```python
import torch

def _softmax(x, axis=-1):
    return torch.softmax(x, dim=axis)
def _gelu(x):
    return torch.nn.functional.gelu(x, approximate="tanh")
def _silu(x):
    return torch.nn.functional.silu(x)
def _sigmoid(x):
    return torch.sigmoid(x)
def _layernorm(x, axis=-1, eps=1e-5):
    m = x.mean(dim=axis, keepdim=True)
    v = x.var(dim=axis, keepdim=True, unbiased=False)
    return (x - m) / torch.sqrt(v + eps)
def _scatter_add(tgt, idx, src, axis=0):
    return tgt.clone().index_add_(axis, idx, src)
def _segment_sum(src, seg, n):
    out = torch.zeros((n,) + src.shape[1:], dtype=src.dtype)
    return out.index_add_(0, seg, src)
def _pad(x, pw):
    flat = tuple(v for pair in reversed(pw) for v in pair)
    return torch.nn.functional.pad(x, flat)

kernel_name = 'parallel_sum__spectral_gfnet__glu_gated_geglu__prompt'

def setup_inputs():

    _w = (lambda a: (lambda t: t.to(torch.bfloat16) if t.is_floating_point() else t)(torch.as_tensor(a)))
    def _A_setup():
        B, S, D = 1, 2048, 512
        Df = D // 2 + 1
        return {
            "x": _w((lambda *s: torch.randn(*s, dtype=torch.bfloat16) * 0.05)(B, S, D)),
            "w_r": _w((lambda *s: torch.randn(*s, dtype=torch.bfloat16) * 0.8)(S, Df) * 0.02),
            "w_i": _w((lambda *s: torch.randn(*s, dtype=torch.bfloat16) * 0.8)(S, Df) * 0.02),
        }
    _A_in = _A_setup()

    def _B_setup():
        B, S, Dm, Df = 1, 2048, 512, 1792
        return {
            "x": _w((lambda *s: torch.randn(*s, dtype=torch.bfloat16) * 0.05)(B, S, Dm)),
            "w_gate": _w((lambda *s: torch.randn(*s, dtype=torch.bfloat16) * 0.4)(Dm, Df) * (Dm ** -0.5)),
            "w_up": _w((lambda *s: torch.randn(*s, dtype=torch.bfloat16) * 0.4)(Dm, Df) * (Dm ** -0.5)),
            "w_down": _w((lambda *s: torch.randn(*s, dtype=torch.bfloat16) * 0.4)(Df, Dm) * (Df ** -0.5)),
        }
    _B_in = _B_setup()

    return {
        "A_x": _A_in["x"],
        "A_w_r": _A_in["w_r"],
        "A_w_i": _A_in["w_i"],
        "B_x": _B_in["x"],
        "B_w_gate": _B_in["w_gate"],
        "B_w_up": _B_in["w_up"],
        "B_w_down": _B_in["w_down"],
    }

def reference(A_x, A_w_r, A_w_i, B_x, B_w_gate, B_w_up, B_w_down):
    def _A_ref(x, w_r, w_i):
        B, S, D = x.shape
        X = (lambda x, axes=(-2,-1): torch.fft.rfft2(x.float(), dim=axes))(x, axes=(-2, -1))
        W = w_r + 1j * w_i
        X = X * W
        y = (lambda x, s, axes=(-2,-1): torch.fft.irfft2(x, s=s, dim=axes).to(torch.bfloat16))(X, (S, D), axes=(-2, -1))
        return y

    def _B_ref(x, w_gate, w_up, w_down):
        g = torch.einsum("bsd,df->bsf", x, w_gate)
        u = torch.einsum("bsd,df->bsf", x, w_up)
        h = _gelu(g) * u
        return torch.einsum("bsf,fd->bsd", h, w_down)

    x = A_x
    xn = _layernorm(x, axis=-1)
    return x + _A_ref(xn, A_w_r, A_w_i) + _B_ref(xn, B_w_gate, B_w_up, B_w_down)
```

```asm
; @launch grid=(256,1,1) block=(512,1,1) lds=163840
.amdgcn_target "amdgcn-amd-amdhsa--gfx950"
.text
.globl parallel_sum__spectral_gfnet__glu_gated_geglu__prompt_kernel
.p2align 8
.type parallel_sum__spectral_gfnet__glu_gated_geglu__prompt_kernel,@function
parallel_sum__spectral_gfnet__glu_gated_geglu__prompt_kernel:
  s_cmp_ge_u32 s2, 256
  s_cbranch_scc1 k_done
  s_load_dwordx2 s[4:5], s[0:1], 72
  s_load_dwordx2 s[6:7], s[0:1], 0
  s_load_dwordx2 s[28:29], s[0:1], 32
  s_load_dwordx2 s[30:31], s[0:1], 40
  s_load_dwordx2 s[54:55], s[0:1], 64
  s_load_dwordx2 s[40:41], s[0:1], 8
  s_load_dwordx2 s[44:45], s[0:1], 16
  s_load_dwordx2 s[56:57], s[0:1], 48
  v_lshrrev_b32 v1, 6, v0
  s_nop 0
  v_readfirstlane_b32 s32, v1
  s_waitcnt lgkmcnt(0)
  v_and_b32 v1, 63, v0
  v_and_b32 v3, 31, v0
  v_bfe_u32 v2, v0, 5, 1
  s_and_b32 s33, s2, 7
  s_lshr_b32 s34, s2, 3
  s_and_b32 s35, s33, 1
  s_lshl_b32 s35, s35, 3
  s_and_b32 s36, s34, 7
  s_add_u32 s35, s35, s36
  s_lshr_b32 s33, s33, 1
  s_lshl_b32 s33, s33, 2
  s_lshr_b32 s34, s34, 3
  s_add_u32 s34, s33, s34
  s_and_b32 s36, s32, 3
  s_lshr_b32 s37, s32, 2
  s_lshr_b32 s49, s35, 1
  s_cmp_lt_u32 s32, 4
  s_cbranch_scc1 p1_roleC
  s_mov_b32 s8, s6
  s_mov_b32 s9, s7
  s_mov_b32 s10, 0x200000
  s_mov_b32 s11, 0x20000
  s_mov_b32 s12, s28
  s_mov_b32 s13, s29
  s_mov_b32 s14, 0x1c0000
  s_mov_b32 s15, 0x20000
  s_mov_b32 s16, s30
  s_mov_b32 s17, s31
  s_mov_b32 s18, 0x1c0000
  s_mov_b32 s19, 0x20000
  s_mov_b32 s50, 0xf3ff3fff
  s_mov_b32 s51, 0xfff3ff3f
  s_lshl_b32 s38, s36, 12
  v_lshrrev_b32 v80, 3, v1
  v_lshlrev_b32 v80, 16, v80
  s_lshl_b32 s60, s35, 2
  s_add_u32 s60, s60, s36
  s_lshl_b32 s60, s60, 10
  v_add_u32 v80, s60, v80
  v_and_b32 v81, 7, v1
  v_lshrrev_b32 v82, 4, v1
  v_xor_b32 v81, v81, v82
  v_lshl_add_u32 v4, v81, 4, v80
  v_xor_b32 v5, 64, v4
  s_lshl_b32 s60, s36, 4
  v_add_u32 v81, s60, v82
  s_movk_i32 s60, 3584
  v_mul_lo_u32 v81, v81, s60
  v_and_b32 v83, 15, v1
  v_lshlrev_b32 v82, 2, v82
  v_xor_b32 v83, v83, v82
  v_lshl_add_u32 v6, v83, 4, v81
  s_mul_i32 s60, s34, 224
  v_add_u32 v6, s60, v6
  s_add_u32 s52, s49, 0
  s_and_b32 s52, s52, 7
  s_mul_i32 s53, s52, 229376
  s_lshl_b32 s52, s52, 7
  s_add_u32 m0, s38, 0
  s_add_u32 s60, s52, 0
  buffer_load_dwordx4 v4, s[8:11], s60 offen lds
  s_add_u32 s60, s53, 0
  s_mov_b64 exec, s[50:51]
  s_add_u32 m0, s38, 16384
  s_nop 0
  buffer_load_dwordx4 v6, s[12:15], s60 offen lds
  s_add_u32 m0, s38, 32768
  s_nop 0
  buffer_load_dwordx4 v6, s[16:19], s60 offen lds
  s_mov_b64 exec, -1
  s_add_u32 m0, s38, 1024
  s_add_u32 s60, s52, 524288
  buffer_load_dwordx4 v5, s[8:11], s60 offen lds
  s_add_u32 s60, s53, 14336
  s_mov_b64 exec, s[50:51]
  s_add_u32 m0, s38, 17408
  s_nop 0
  buffer_load_dwordx4 v6, s[12:15], s60 offen lds
  s_add_u32 m0, s38, 33792
  s_nop 0
  buffer_load_dwordx4 v6, s[16:19], s60 offen lds
  s_mov_b64 exec, -1
  s_add_u32 m0, s38, 2048
  s_add_u32 s60, s52, 1048576
  buffer_load_dwordx4 v4, s[8:11], s60 offen lds
  s_add_u32 s60, s53, 28672
  s_mov_b64 exec, s[50:51]
  s_add_u32 m0, s38, 18432
  s_nop 0
  buffer_load_dwordx4 v6, s[12:15], s60 offen lds
  s_add_u32 m0, s38, 34816
  s_nop 0
  buffer_load_dwordx4 v6, s[16:19], s60 offen lds
  s_mov_b64 exec, -1
  s_add_u32 m0, s38, 3072
  s_add_u32 s60, s52, 1572864
  buffer_load_dwordx4 v5, s[8:11], s60 offen lds
  s_add_u32 s60, s53, 43008
  s_mov_b64 exec, s[50:51]
  s_add_u32 m0, s38, 19456
  s_nop 0
  buffer_load_dwordx4 v6, s[12:15], s60 offen lds
  s_add_u32 m0, s38, 35840
  s_nop 0
  buffer_load_dwordx4 v6, s[16:19], s60 offen lds
  s_mov_b64 exec, -1
  s_lshl_b32 s33, s34, 3
  s_lshl_b32 s60, s36, 1
  s_add_u32 s33, s33, s60
  s_lshl_b32 s60, s35, 7
  s_add_u32 s64, s60, s33
  v_lshlrev_b32 v80, 4, v1
  s_add_u32 s60, s64, 0
  s_and_b32 s61, s60, 31
  s_lshl_b32 s61, s61, 6
  s_lshr_b32 s60, s60, 5
  s_add_u32 s60, s60, s61
  s_lshl_b32 s60, s60, 10
  buffer_load_dwordx4 v[128:131], v80, s[8:11], s60 offen
  s_add_u32 s60, s64, 1
  s_and_b32 s61, s60, 31
  s_lshl_b32 s61, s61, 6
  s_lshr_b32 s60, s60, 5
  s_add_u32 s60, s60, s61
  s_lshl_b32 s60, s60, 10
  buffer_load_dwordx4 v[132:135], v80, s[8:11], s60 offen
  s_add_u32 s52, s49, 1
  s_and_b32 s52, s52, 7
  s_mul_i32 s53, s52, 229376
  s_lshl_b32 s52, s52, 7
  s_add_u32 m0, s38, 49152
  s_add_u32 s60, s52, 0
  buffer_load_dwordx4 v4, s[8:11], s60 offen lds
  s_add_u32 s60, s53, 0
  s_mov_b64 exec, s[50:51]
  s_add_u32 m0, s38, 65536
  s_nop 0
  buffer_load_dwordx4 v6, s[12:15], s60 offen lds
  s_add_u32 m0, s38, 81920
  s_nop 0
  buffer_load_dwordx4 v6, s[16:19], s60 offen lds
  s_mov_b64 exec, -1
  s_add_u32 m0, s38, 50176
  s_add_u32 s60, s52, 524288
  buffer_load_dwordx4 v5, s[8:11], s60 offen lds
  s_add_u32 s60, s53, 14336
  s_mov_b64 exec, s[50:51]
  s_add_u32 m0, s38, 66560
  s_nop 0
  buffer_load_dwordx4 v6, s[12:15], s60 offen lds
  s_add_u32 m0, s38, 82944
  s_nop 0
  buffer_load_dwordx4 v6, s[16:19], s60 offen lds
  s_mov_b64 exec, -1
  s_add_u32 m0, s38, 51200
  s_add_u32 s60, s52, 1048576
  buffer_load_dwordx4 v4, s[8:11], s60 offen lds
  s_add_u32 s60, s53, 28672
  s_mov_b64 exec, s[50:51]
  s_add_u32 m0, s38, 67584
  s_nop 0
  buffer_load_dwordx4 v6, s[12:15], s60 offen lds
  s_add_u32 m0, s38, 83968
  s_nop 0
  buffer_load_dwordx4 v6, s[16:19], s60 offen lds
  s_mov_b64 exec, -1
  s_add_u32 m0, s38, 52224
  s_add_u32 s60, s52, 1572864
  buffer_load_dwordx4 v5, s[8:11], s60 offen lds
  s_add_u32 s60, s53, 43008
  s_mov_b64 exec, s[50:51]
  s_add_u32 m0, s38, 68608
  s_nop 0
  buffer_load_dwordx4 v6, s[12:15], s60 offen lds
  s_add_u32 m0, s38, 84992
  s_nop 0
  buffer_load_dwordx4 v6, s[16:19], s60 offen lds
  s_mov_b64 exec, -1
  s_cmp_lt_u32 s32, 6
  s_cbranch_scc1 p1H_nf
  s_and_b32 s39, s32, 1
  s_lshl_b32 s33, s49, 6
  s_lshl_b32 s60, s39, 5
  s_add_u32 s33, s33, s60
  v_add_u32 v82, s33, v3
  v_cvt_f32_u32 v12, v82
  v_mul_f32 v12, 0x3b000000, v12
  s_lshl_b32 s33, s34, 4
  v_lshlrev_b32 v83, 3, v2
  v_add_u32 v83, s33, v83
  v_cvt_f32_u32 v13, v83
  v_mov_b32 v14, 0xffff
  v_mul_f32 v84, v12, v13
  v_cos_f32 v86, v84
  v_sin_f32 v88, v84
  v_add_f32 v84, v84, v12
  v_cos_f32 v87, v84
  v_sin_f32 v89, v84
  v_add_f32 v84, v84, v12
  v_cvt_pk_bf16_f32 v32, v86, v87
  v_cvt_pk_bf16_f32 v36, -v88, -v89
  v_cos_f32 v86, v84
  v_sin_f32 v88, v84
  v_add_f32 v84, v84, v12
  v_cos_f32 v87, v84
  v_sin_f32 v89, v84
  v_add_f32 v84, v84, v12
  v_cvt_pk_bf16_f32 v33, v86, v87
  v_cvt_pk_bf16_f32 v37, -v88, -v89
  v_cos_f32 v86, v84
  v_sin_f32 v88, v84
  v_add_f32 v84, v84, v12
  v_cos_f32 v87, v84
  v_sin_f32 v89, v84
  v_add_f32 v84, v84, v12
  v_cvt_pk_bf16_f32 v34, v86, v87
  v_cvt_pk_bf16_f32 v38, -v88, -v89
  v_cos_f32 v86, v84
  v_sin_f32 v88, v84
  v_add_f32 v84, v84, v12
  v_cos_f32 v87, v84
  v_sin_f32 v89, v84
  v_add_f32 v84, v84, v12
  v_cvt_pk_bf16_f32 v35, v86, v87
  v_cvt_pk_bf16_f32 v39, -v88, -v89
  v_and_b32 v85, 1, v3
  v_lshlrev_b32 v85, 15, v85
  v_or_b32 v85, 0x3f80, v85
  v_bfi_b32 v85, v14, v85, v36
  v_cmp_eq_u32 vcc, 0, v83
  s_nop 1
  v_cndmask_b32 v36, v36, v85, vcc
  v_add_f32 v12, 0x3e000000, v12
  v_fract_f32 v12, v12
  v_mul_f32 v84, v12, v13
  v_cos_f32 v86, v84
  v_sin_f32 v88, v84
  v_add_f32 v84, v84, v12
  v_cos_f32 v87, v84
  v_sin_f32 v89, v84
  v_add_f32 v84, v84, v12
  v_cvt_pk_bf16_f32 v40, v86, v87
  v_cvt_pk_bf16_f32 v44, -v88, -v89
  v_cos_f32 v86, v84
  v_sin_f32 v88, v84
  v_add_f32 v84, v84, v12
  v_cos_f32 v87, v84
  v_sin_f32 v89, v84
  v_add_f32 v84, v84, v12
  v_cvt_pk_bf16_f32 v41, v86, v87
  v_cvt_pk_bf16_f32 v45, -v88, -v89
  v_cos_f32 v86, v84
  v_sin_f32 v88, v84
  v_add_f32 v84, v84, v12
  v_cos_f32 v87, v84
  v_sin_f32 v89, v84
  v_add_f32 v84, v84, v12
  v_cvt_pk_bf16_f32 v42, v86, v87
  v_cvt_pk_bf16_f32 v46, -v88, -v89
  v_cos_f32 v86, v84
  v_sin_f32 v88, v84
  v_add_f32 v84, v84, v12
  v_cos_f32 v87, v84
  v_sin_f32 v89, v84
  v_add_f32 v84, v84, v12
  v_cvt_pk_bf16_f32 v43, v86, v87
  v_cvt_pk_bf16_f32 v47, -v88, -v89
  v_and_b32 v85, 1, v3
  v_lshlrev_b32 v85, 15, v85
  v_or_b32 v85, 0x3f80, v85
  v_bfi_b32 v85, v14, v85, v44
  v_cmp_eq_u32 vcc, 0, v83
  s_nop 1
  v_cndmask_b32 v44, v44, v85, vcc
  s_lshl_b32 s60, s39, 5
  v_add_u32 v82, s60, v3
  v_and_b32 v83, 3, v82
  v_lshlrev_b32 v83, 2, v83
  v_add_u32 v84, 14, v2
  v_xor_b32 v83, v83, v84
  v_lshlrev_b32 v83, 4, v83
  v_lshl_add_u32 v83, v82, 8, v83
  v_add_u32 v8, 16384, v83
  v_add_u32 v9, 65536, v83
  v_add_u32 v10, 114688, v83
p1H_nf:
  s_cmp_lg_u32 s2, 0
  s_cbranch_scc1 p1H_non
  s_cmp_lg_u32 s32, 7
  s_cbranch_scc1 p1H_non
  s_add_u32 s62, s4, 0x1000000
  s_addc_u32 s63, s5, 0
  v_lshlrev_b32 v80, 7, v1
  v_mov_b32 v81, 0
  global_store_dword v80, v81, s[62:63] sc1
  v_add_u32 v80, 8192, v80
  global_store_dword v80, v81, s[62:63] sc1
  v_add_u32 v80, 8192, v80
  global_store_dword v80, v81, s[62:63] sc1
  v_add_u32 v80, 8192, v80
  global_store_dword v80, v81, s[62:63] sc1
  v_add_u32 v80, 8192, v80
  s_mov_b64 exec, 1
  s_waitcnt vmcnt(0)
  v_mov_b32 v80, 0
  v_mov_b32 v81, 1
  global_store_dword v80, v81, s[54:55] sc1
  s_mov_b64 exec, -1
p1H_non:
  s_waitcnt vmcnt(14) lgkmcnt(0)
  s_barrier
  v_mov_b32 v21, 0
  s_mov_b64 exec, 1
  global_load_dword v20, v21, s[54:55] sc1
  s_mov_b64 exec, -1
  s_cmp_lt_u32 s32, 6
  s_cbranch_scc1 p1H_fg1
  v_bfi_b32 v48, v14, v32, v36
  v_bfi_b32 v49, v14, v33, v37
  v_xor_b32 v49, 0x80008000, v49
  v_bfi_b32 v50, v14, v34, v38
  v_bfi_b32 v51, v14, v35, v39
  v_xor_b32 v51, 0x80008000, v51
  ds_write_b128 v10, v[48:51] offset:0
  v_bfi_b32 v52, v14, v36, v32
  v_xor_b32 v52, 0x80000000, v52
  v_bfi_b32 v53, v14, v37, v33
  v_xor_b32 v53, 0x8000, v53
  v_bfi_b32 v54, v14, v38, v34
  v_xor_b32 v54, 0x80000000, v54
  v_bfi_b32 v55, v14, v39, v35
  v_xor_b32 v55, 0x8000, v55
  ds_write_b128 v10, v[52:55] offset:16384
p1H_fg1:
  s_add_u32 s52, s49, 2
  s_and_b32 s52, s52, 7
  s_mul_i32 s53, s52, 229376
  s_lshl_b32 s52, s52, 7
  s_add_u32 m0, s38, 98304
  s_add_u32 s60, s52, 0
  buffer_load_dwordx4 v4, s[8:11], s60 offen lds
  s_add_u32 s60, s53, 0
  s_mov_b64 exec, s[50:51]
  s_add_u32 m0, s38, 114688
  s_nop 0
  buffer_load_dwordx4 v6, s[12:15], s60 offen lds
  s_add_u32 m0, s38, 131072
  s_nop 0
  buffer_load_dwordx4 v6, s[16:19], s60 offen lds
  s_mov_b64 exec, -1
  s_add_u32 m0, s38, 99328
  s_add_u32 s60, s52, 524288
  buffer_load_dwordx4 v5, s[8:11], s60 offen lds
  s_add_u32 s60, s53, 14336
  s_mov_b64 exec, s[50:51]
  s_add_u32 m0, s38, 115712
  s_nop 0
  buffer_load_dwordx4 v6, s[12:15], s60 offen lds
  s_add_u32 m0, s38, 132096
  s_nop 0
  buffer_load_dwordx4 v6, s[16:19], s60 offen lds
  s_mov_b64 exec, -1
  s_add_u32 m0, s38, 100352
  s_add_u32 s60, s52, 1048576
  buffer_load_dwordx4 v4, s[8:11], s60 offen lds
  s_add_u32 s60, s53, 28672
  s_mov_b64 exec, s[50:51]
  s_add_u32 m0, s38, 116736
  s_nop 0
  buffer_load_dwordx4 v6, s[12:15], s60 offen lds
  s_add_u32 m0, s38, 133120
  s_nop 0
  buffer_load_dwordx4 v6, s[16:19], s60 offen lds
  s_mov_b64 exec, -1
  s_add_u32 m0, s38, 101376
  s_add_u32 s60, s52, 1572864
  buffer_load_dwordx4 v5, s[8:11], s60 offen lds
  s_add_u32 s60, s53, 43008
  s_mov_b64 exec, s[50:51]
  s_add_u32 m0, s38, 117760
  s_nop 0
  buffer_load_dwordx4 v6, s[12:15], s60 offen lds
  s_add_u32 m0, s38, 134144
  s_nop 0
  buffer_load_dwordx4 v6, s[16:19], s60 offen lds
  s_mov_b64 exec, -1
  s_waitcnt vmcnt(25)
  v_lshlrev_b32 v94, 16, v128
  v_and_b32 v95, 0xffff0000, v128
  v_add_f32 v56, v94, v95
  v_mul_f32 v57, v94, v94
  v_fmac_f32 v57, v95, v95
  v_lshlrev_b32 v96, 16, v132
  v_and_b32 v97, 0xffff0000, v132
  v_add_f32 v58, v96, v97
  v_mul_f32 v59, v96, v96
  v_fmac_f32 v59, v97, v97
  v_lshlrev_b32 v94, 16, v129
  v_and_b32 v95, 0xffff0000, v129
  v_add_f32 v56, v56, v94
  v_fmac_f32 v57, v94, v94
  v_add_f32 v56, v56, v95
  v_fmac_f32 v57, v95, v95
  v_lshlrev_b32 v96, 16, v133
  v_and_b32 v97, 0xffff0000, v133
  v_add_f32 v58, v58, v96
  v_fmac_f32 v59, v96, v96
  v_add_f32 v58, v58, v97
  v_fmac_f32 v59, v97, v97
  v_lshlrev_b32 v94, 16, v130
  v_and_b32 v95, 0xffff0000, v130
  v_add_f32 v56, v56, v94
  v_fmac_f32 v57, v94, v94
  v_add_f32 v56, v56, v95
  v_fmac_f32 v57, v95, v95
  v_lshlrev_b32 v96, 16, v134
  v_and_b32 v97, 0xffff0000, v134
  v_add_f32 v58, v58, v96
  v_fmac_f32 v59, v96, v96
  v_add_f32 v58, v58, v97
  v_fmac_f32 v59, v97, v97
  v_lshlrev_b32 v94, 16, v131
  v_and_b32 v95, 0xffff0000, v131
  v_add_f32 v56, v56, v94
  v_fmac_f32 v57, v94, v94
  v_add_f32 v56, v56, v95
  v_fmac_f32 v57, v95, v95
  v_lshlrev_b32 v96, 16, v135
  v_and_b32 v97, 0xffff0000, v135
  v_add_f32 v58, v58, v96
  v_fmac_f32 v59, v96, v96
  v_add_f32 v58, v58, v97
  v_fmac_f32 v59, v97, v97
  v_add_f32_dpp v56, v56, v56 row_ror:8 row_mask:0xf bank_mask:0xf
  v_add_f32_dpp v57, v57, v57 row_ror:8 row_mask:0xf bank_mask:0xf
  v_add_f32_dpp v58, v58, v58 row_ror:8 row_mask:0xf bank_mask:0xf
  v_add_f32_dpp v59, v59, v59 row_ror:8 row_mask:0xf bank_mask:0xf
  v_add_f32_dpp v56, v56, v56 row_ror:4 row_mask:0xf bank_mask:0xf
  v_add_f32_dpp v57, v57, v57 row_ror:4 row_mask:0xf bank_mask:0xf
  v_add_f32_dpp v58, v58, v58 row_ror:4 row_mask:0xf bank_mask:0xf
  v_add_f32_dpp v59, v59, v59 row_ror:4 row_mask:0xf bank_mask:0xf
  v_add_f32_dpp v56, v56, v56 row_ror:2 row_mask:0xf bank_mask:0xf
  v_add_f32_dpp v57, v57, v57 row_ror:2 row_mask:0xf bank_mask:0xf
  v_add_f32_dpp v58, v58, v58 row_ror:2 row_mask:0xf bank_mask:0xf
  v_add_f32_dpp v59, v59, v59 row_ror:2 row_mask:0xf bank_mask:0xf
  v_add_f32_dpp v56, v56, v56 row_ror:1 row_mask:0xf bank_mask:0xf
  v_add_f32_dpp v57, v57, v57 row_ror:1 row_mask:0xf bank_mask:0xf
  v_add_f32_dpp v58, v58, v58 row_ror:1 row_mask:0xf bank_mask:0xf
  v_add_f32_dpp v59, v59, v59 row_ror:1 row_mask:0xf bank_mask:0xf
  v_mov_b32 v94, v56
  v_mov_b32 v95, v57
  v_mov_b32 v96, v58
  v_mov_b32 v97, v59
  v_permlane16_swap_b32 v56, v94
  v_permlane16_swap_b32 v57, v95
  v_permlane16_swap_b32 v58, v96
  v_permlane16_swap_b32 v59, v97
  v_add_f32 v56, v56, v94
  v_add_f32 v57, v57, v95
  v_add_f32 v58, v58, v96
  v_add_f32 v59, v59, v97
  v_mov_b32 v94, v56
  v_mov_b32 v95, v57
  v_mov_b32 v96, v58
  v_mov_b32 v97, v59
  v_permlane32_swap_b32 v56, v94
  v_permlane32_swap_b32 v57, v95
  v_permlane32_swap_b32 v58, v96
  v_permlane32_swap_b32 v59, v97
  v_add_f32 v56, v56, v94
  v_add_f32 v57, v57, v95
  v_add_f32 v58, v58, v96
  v_add_f32 v59, v59, v97
  v_and_b32 v94, 1, v1
  v_cmp_eq_u32 vcc, 1, v94
  s_nop 1
  v_cndmask_b32 v56, v56, v58, vcc
  v_cndmask_b32 v57, v57, v59, vcc
  v_mul_f32 v94, 0x3b000000, v56
  v_mul_f32 v95, 0x3b000000, v57
  v_fma_f32 v95, -v94, v94, v95
  v_max_f32 v95, 0, v95
  v_cvt_pk_bf16_f32 v94, v94, v95
  v_and_b32 v95, 0xffff0000, v94
  v_lshlrev_b32 v94, 16, v94
  v_sub_f32 v56, 0, v94
  v_add_f32 v95, 0x3727c5ac, v95
  v_cvt_pk_bf16_f32 v95, v95, v95
  v_and_b32 v95, 0xffff0000, v95
  v_sqrt_f32 v95, v95
  s_nop 0
  v_cvt_pk_bf16_f32 v95, v95, v95
  v_and_b32 v57, 0xffff0000, v95
  s_lshl_b32 s60, s64, 3
  s_add_u32 s60, s60, 16875520
  s_add_u32 s62, s4, s60
  s_addc_u32 s63, s5, 0
  v_lshlrev_b32 v94, 3, v1
  s_mov_b64 exec, 3
  global_store_dwordx2 v94, v[56:57], s[62:63] sc1
  s_mov_b64 exec, -1
  s_waitcnt vmcnt(14) lgkmcnt(0)
  s_barrier
  s_cmp_lt_u32 s32, 6
  s_cbranch_scc1 p1H_fg2
  v_bfi_b32 v48, v14, v40, v44
  v_bfi_b32 v49, v14, v41, v45
  v_xor_b32 v49, 0x80008000, v49
  v_bfi_b32 v50, v14, v42, v46
  v_bfi_b32 v51, v14, v43, v47
  v_xor_b32 v51, 0x80008000, v51
  ds_write_b128 v8, v[48:51] offset:0
  v_bfi_b32 v52, v14, v44, v40
  v_xor_b32 v52, 0x80000000, v52
  v_bfi_b32 v53, v14, v45, v41
  v_xor_b32 v53, 0x8000, v53
  v_bfi_b32 v54, v14, v46, v42
  v_xor_b32 v54, 0x80000000, v54
  v_bfi_b32 v55, v14, v47, v43
  v_xor_b32 v55, 0x8000, v55
  ds_write_b128 v8, v[52:55] offset:16384
p1H_fg2:
  s_add_u32 s52, s49, 3
  s_and_b32 s52, s52, 7
  s_mul_i32 s53, s52, 229376
  s_lshl_b32 s52, s52, 7
  s_add_u32 m0, s38, 0
  s_add_u32 s60, s52, 0
  buffer_load_dwordx4 v4, s[8:11], s60 offen lds
  s_add_u32 s60, s53, 0
  s_mov_b64 exec, s[50:51]
  s_add_u32 m0, s38, 16384
  s_nop 0
  buffer_load_dwordx4 v6, s[12:15], s60 offen lds
  s_add_u32 m0, s38, 32768
  s_nop 0
  buffer_load_dwordx4 v6, s[16:19], s60 offen lds
  s_mov_b64 exec, -1
  s_add_u32 m0, s38, 1024
  s_add_u32 s60, s52, 524288
  buffer_load_dwordx4 v5, s[8:11], s60 offen lds
  s_add_u32 s60, s53, 14336
  s_mov_b64 exec, s[50:51]
  s_add_u32 m0, s38, 17408
  s_nop 0
  buffer_load_dwordx4 v6, s[12:15], s60 offen lds
  s_add_u32 m0, s38, 33792
  s_nop 0
  buffer_load_dwordx4 v6, s[16:19], s60 offen lds
  s_mov_b64 exec, -1
  s_add_u32 m0, s38, 2048
  s_add_u32 s60, s52, 1048576
  buffer_load_dwordx4 v4, s[8:11], s60 offen lds
  s_add_u32 s60, s53, 28672
  s_mov_b64 exec, s[50:51]
  s_add_u32 m0, s38, 18432
  s_nop 0
  buffer_load_dwordx4 v6, s[12:15], s60 offen lds
  s_add_u32 m0, s38, 34816
  s_nop 0
  buffer_load_dwordx4 v6, s[16:19], s60 offen lds
  s_mov_b64 exec, -1
  s_add_u32 m0, s38, 3072
  s_add_u32 s60, s52, 1572864
  buffer_load_dwordx4 v5, s[8:11], s60 offen lds
  s_add_u32 s60, s53, 43008
  s_mov_b64 exec, s[50:51]
  s_add_u32 m0, s38, 19456
  s_nop 0
  buffer_load_dwordx4 v6, s[12:15], s60 offen lds
  s_add_u32 m0, s38, 35840
  s_nop 0
  buffer_load_dwordx4 v6, s[16:19], s60 offen lds
  s_mov_b64 exec, -1
  s_waitcnt vmcnt(13) lgkmcnt(0)
  s_barrier
  s_cmp_lt_u32 s32, 6
  s_cbranch_scc1 p1H_fg3
  v_xor_b32 v48, 0x80000000, v32
  v_xor_b32 v49, 0x80000000, v33
  v_xor_b32 v50, 0x80000000, v34
  v_xor_b32 v51, 0x80000000, v35
  ds_write_b128 v9, v[48:51] offset:0
  v_xor_b32 v52, 0x80000000, v36
  v_xor_b32 v53, 0x80000000, v37
  v_xor_b32 v54, 0x80000000, v38
  v_xor_b32 v55, 0x80000000, v39
  ds_write_b128 v9, v[52:55] offset:16384
p1H_fg3:
  s_add_u32 s52, s49, 4
  s_and_b32 s52, s52, 7
  s_mul_i32 s53, s52, 229376
  s_lshl_b32 s52, s52, 7
  s_add_u32 m0, s38, 49152
  s_add_u32 s60, s52, 0
  buffer_load_dwordx4 v4, s[8:11], s60 offen lds
  s_add_u32 s60, s53, 0
  s_mov_b64 exec, s[50:51]
  s_add_u32 m0, s38, 65536
  s_nop 0
  buffer_load_dwordx4 v6, s[12:15], s60 offen lds
  s_add_u32 m0, s38, 81920
  s_nop 0
  buffer_load_dwordx4 v6, s[16:19], s60 offen lds
  s_mov_b64 exec, -1
  s_add_u32 m0, s38, 50176
  s_add_u32 s60, s52, 524288
  buffer_load_dwordx4 v5, s[8:11], s60 offen lds
  s_add_u32 s60, s53, 14336
  s_mov_b64 exec, s[50:51]
  s_add_u32 m0, s38, 66560
  s_nop 0
  buffer_load_dwordx4 v6, s[12:15], s60 offen lds
  s_add_u32 m0, s38, 82944
  s_nop 0
  buffer_load_dwordx4 v6, s[16:19], s60 offen lds
  s_mov_b64 exec, -1
  s_add_u32 m0, s38, 51200
  s_add_u32 s60, s52, 1048576
  buffer_load_dwordx4 v4, s[8:11], s60 offen lds
  s_add_u32 s60, s53, 28672
  s_mov_b64 exec, s[50:51]
  s_add_u32 m0, s38, 67584
  s_nop 0
  buffer_load_dwordx4 v6, s[12:15], s60 offen lds
  s_add_u32 m0, s38, 83968
  s_nop 0
  buffer_load_dwordx4 v6, s[16:19], s60 offen lds
  s_mov_b64 exec, -1
  s_add_u32 m0, s38, 52224
  s_add_u32 s60, s52, 1572864
  buffer_load_dwordx4 v5, s[8:11], s60 offen lds
  s_add_u32 s60, s53, 43008
  s_mov_b64 exec, s[50:51]
  s_add_u32 m0, s38, 68608
  s_nop 0
  buffer_load_dwordx4 v6, s[12:15], s60 offen lds
  s_add_u32 m0, s38, 84992
  s_nop 0
  buffer_load_dwordx4 v6, s[16:19], s60 offen lds
  s_mov_b64 exec, -1
  s_waitcnt vmcnt(12) lgkmcnt(0)
  s_barrier
  s_cmp_lg_u32 s32, 4
  s_cbranch_scc1 p1H_f0
  v_readfirstlane_b32 s3, v20
  s_nop 2
  s_cmp_lg_u32 s3, 0
  s_cbranch_scc1 nd_2
  s_mov_b32 s58, 0
nl_1:
  global_load_dword v20, v21, s[54:55] sc1
  s_waitcnt vmcnt(0)
  v_readfirstlane_b32 s3, v20
  s_nop 2
  s_cmp_lg_u32 s3, 0
  s_cbranch_scc1 nd_2
  s_add_u32 s58, s58, 1
  s_cmp_lt_u32 s58, 8192
  s_cbranch_scc1 nl_1
nd_2:
  s_add_u32 s62, s4, 0x1000000
  s_addc_u32 s63, s5, 0
  s_lshl_b32 s59, s35, 7
  v_mov_b32 v94, s59
  v_mov_b32 v95, 1
  s_mov_b64 exec, 1
  global_atomic_add v94, v95, s[62:63] sc1
  s_mov_b64 exec, -1
  s_add_u32 s61, s34, 16
  s_add_u32 s62, s4, 0x1000000
  s_addc_u32 s63, s5, 0
  s_lshl_b32 s59, s61, 7
  v_mov_b32 v94, s59
  v_mov_b32 v95, 1
  s_mov_b64 exec, 1
  global_atomic_add v94, v95, s[62:63] sc1
  s_mov_b64 exec, -1
p1H_f0:
  s_cmp_lt_u32 s32, 6
  s_cbranch_scc1 p1H_fg4
  v_xor_b32 v48, 0x80000000, v40
  v_xor_b32 v49, 0x80000000, v41
  v_xor_b32 v50, 0x80000000, v42
  v_xor_b32 v51, 0x80000000, v43
  ds_write_b128 v10, v[48:51] offset:0
  v_xor_b32 v52, 0x80000000, v44
  v_xor_b32 v53, 0x80000000, v45
  v_xor_b32 v54, 0x80000000, v46
  v_xor_b32 v55, 0x80000000, v47
  ds_write_b128 v10, v[52:55] offset:16384
p1H_fg4:
  s_add_u32 s52, s49, 5
  s_and_b32 s52, s52, 7
  s_mul_i32 s53, s52, 229376
  s_lshl_b32 s52, s52, 7
  s_add_u32 m0, s38, 98304
  s_add_u32 s60, s52, 0
  buffer_load_dwordx4 v4, s[8:11], s60 offen lds
  s_add_u32 s60, s53, 0
  s_mov_b64 exec, s[50:51]
  s_add_u32 m0, s38, 114688
  s_nop 0
  buffer_load_dwordx4 v6, s[12:15], s60 offen lds
  s_add_u32 m0, s38, 131072
  s_nop 0
  buffer_load_dwordx4 v6, s[16:19], s60 offen lds
  s_mov_b64 exec, -1
  s_add_u32 m0, s38, 99328
  s_add_u32 s60, s52, 524288
  buffer_load_dwordx4 v5, s[8:11], s60 offen lds
  s_add_u32 s60, s53, 14336
  s_mov_b64 exec, s[50:51]
  s_add_u32 m0, s38, 115712
  s_nop 0
  buffer_load_dwordx4 v6, s[12:15], s60 offen lds
  s_add_u32 m0, s38, 132096
  s_nop 0
  buffer_load_dwordx4 v6, s[16:19], s60 offen lds
  s_mov_b64 exec, -1
  s_add_u32 m0, s38, 100352
  s_add_u32 s60, s52, 1048576
  buffer_load_dwordx4 v4, s[8:11], s60 offen lds
  s_add_u32 s60, s53, 28672
  s_mov_b64 exec, s[50:51]
  s_add_u32 m0, s38, 116736
  s_nop 0
  buffer_load_dwordx4 v6, s[12:15], s60 offen lds
  s_add_u32 m0, s38, 133120
  s_nop 0
  buffer_load_dwordx4 v6, s[16:19], s60 offen lds
  s_mov_b64 exec, -1
  s_add_u32 m0, s38, 101376
  s_add_u32 s60, s52, 1572864
  buffer_load_dwordx4 v5, s[8:11], s60 offen lds
  s_add_u32 s60, s53, 43008
  s_mov_b64 exec, s[50:51]
  s_add_u32 m0, s38, 117760
  s_nop 0
  buffer_load_dwordx4 v6, s[12:15], s60 offen lds
  s_add_u32 m0, s38, 134144
  s_nop 0
  buffer_load_dwordx4 v6, s[16:19], s60 offen lds
  s_mov_b64 exec, -1
  s_waitcnt vmcnt(12) lgkmcnt(0)
  s_barrier
  s_cmp_lt_u32 s32, 6
  s_cbranch_scc1 p1H_fg5
  v_bfi_b32 v48, v14, v32, v36
  v_xor_b32 v48, 0x80000000, v48
  v_bfi_b32 v49, v14, v33, v37
  v_xor_b32 v49, 0x8000, v49
  v_bfi_b32 v50, v14, v34, v38
  v_xor_b32 v50, 0x80000000, v50
  v_bfi_b32 v51, v14, v35, v39
  v_xor_b32 v51, 0x8000, v51
  ds_write_b128 v8, v[48:51] offset:0
  v_bfi_b32 v52, v14, v36, v32
  v_bfi_b32 v53, v14, v37, v33
  v_xor_b32 v53, 0x80008000, v53
  v_bfi_b32 v54, v14, v38, v34
  v_bfi_b32 v55, v14, v39, v35
  v_xor_b32 v55, 0x80008000, v55
  ds_write_b128 v8, v[52:55] offset:16384
p1H_fg5:
  s_add_u32 s52, s49, 6
  s_and_b32 s52, s52, 7
  s_mul_i32 s53, s52, 229376
  s_lshl_b32 s52, s52, 7
  s_add_u32 m0, s38, 0
  s_add_u32 s60, s52, 0
  buffer_load_dwordx4 v4, s[8:11], s60 offen lds
  s_add_u32 s60, s53, 0
  s_mov_b64 exec, s[50:51]
  s_add_u32 m0, s38, 16384
  s_nop 0
  buffer_load_dwordx4 v6, s[12:15], s60 offen lds
  s_add_u32 m0, s38, 32768
  s_nop 0
  buffer_load_dwordx4 v6, s[16:19], s60 offen lds
  s_mov_b64 exec, -1
  s_add_u32 m0, s38, 1024
  s_add_u32 s60, s52, 524288
  buffer_load_dwordx4 v5, s[8:11], s60 offen lds
  s_add_u32 s60, s53, 14336
  s_mov_b64 exec, s[50:51]
  s_add_u32 m0, s38, 17408
  s_nop 0
  buffer_load_dwordx4 v6, s[12:15], s60 offen lds
  s_add_u32 m0, s38, 33792
  s_nop 0
  buffer_load_dwordx4 v6, s[16:19], s60 offen lds
  s_mov_b64 exec, -1
  s_add_u32 m0, s38, 2048
  s_add_u32 s60, s52, 1048576
  buffer_load_dwordx4 v4, s[8:11], s60 offen lds
  s_add_u32 s60, s53, 28672
  s_mov_b64 exec, s[50:51]
  s_add_u32 m0, s38, 18432
  s_nop 0
  buffer_load_dwordx4 v6, s[12:15], s60 offen lds
  s_add_u32 m0, s38, 34816
  s_nop 0
  buffer_load_dwordx4 v6, s[16:19], s60 offen lds
  s_mov_b64 exec, -1
  s_add_u32 m0, s38, 3072
  s_add_u32 s60, s52, 1572864
  buffer_load_dwordx4 v5, s[8:11], s60 offen lds
  s_add_u32 s60, s53, 43008
  s_mov_b64 exec, s[50:51]
  s_add_u32 m0, s38, 19456
  s_nop 0
  buffer_load_dwordx4 v6, s[12:15], s60 offen lds
  s_add_u32 m0, s38, 35840
  s_nop 0
  buffer_load_dwordx4 v6, s[16:19], s60 offen lds
  s_mov_b64 exec, -1
  s_bfe_u32 s60, s2, 0x30003
  s_mul_i32 s60, s60, 224
  s_mul_i32 s61, s36, 56
  s_add_u32 s60, s60, s61
  v_add_u32 v80, s60, v1
  v_lshlrev_b32 v80, 10, v80
  s_bfe_u32 s60, s2, 0x10002
  s_lshl_b32 s60, s60, 2
  s_lshr_b32 s61, s2, 6
  s_add_u32 s60, s60, s61
  s_lshl_b32 s60, s60, 7
  v_add_u32 v80, s60, v80
  s_mov_b32 s20, s56
  s_mov_b32 s21, s57
  s_mov_b32 s22, 0x1c0000
  s_mov_b32 s23, 0x20000
  buffer_load_dword v82, v80, s[20:23], 0 offen
  s_waitcnt vmcnt(13) lgkmcnt(0)
  s_barrier
  s_lshl_b32 s60, s35, 7
  s_add_u32 s61, s34, 16
  s_lshl_b32 s61, s61, 7
  v_mov_b32 v23, s61
  v_mov_b32 v22, s60
  v_cmp_eq_u32 vcc, 0, v1
  s_nop 1
  v_cndmask_b32 v23, v23, v22, vcc
  v_mov_b32 v25, 16
  s_cmp_lg_u32 s32, 4
  s_cbranch_scc1 p1H_sp
  s_add_u32 s62, s4, 0x1000000
  s_addc_u32 s63, s5, 0
  s_mov_b64 exec, 3
  global_load_dword v24, v23, s[62:63] sc1
  s_mov_b64 exec, -1
p1H_sp:
  s_cmp_lt_u32 s32, 6
  s_cbranch_scc1 p1H_fg6
  v_bfi_b32 v48, v14, v40, v44
  v_xor_b32 v48, 0x80000000, v48
  v_bfi_b32 v49, v14, v41, v45
  v_xor_b32 v49, 0x8000, v49
  v_bfi_b32 v50, v14, v42, v46
  v_xor_b32 v50, 0x80000000, v50
  v_bfi_b32 v51, v14, v43, v47
  v_xor_b32 v51, 0x8000, v51
  ds_write_b128 v9, v[48:51] offset:0
  v_bfi_b32 v52, v14, v44, v40
  v_bfi_b32 v53, v14, v45, v41
  v_xor_b32 v53, 0x80008000, v53
  v_bfi_b32 v54, v14, v46, v42
  v_bfi_b32 v55, v14, v47, v43
  v_xor_b32 v55, 0x80008000, v55
  ds_write_b128 v9, v[52:55] offset:16384
p1H_fg6:
  s_add_u32 s52, s49, 7
  s_and_b32 s52, s52, 7
  s_mul_i32 s53, s52, 229376
  s_lshl_b32 s52, s52, 7
  s_add_u32 m0, s38, 49152
  s_add_u32 s60, s52, 0
  buffer_load_dwordx4 v4, s[8:11], s60 offen lds
  s_add_u32 s60, s53, 0
  s_mov_b64 exec, s[50:51]
  s_add_u32 m0, s38, 65536
  s_nop 0
  buffer_load_dwordx4 v6, s[12:15], s60 offen lds
  s_add_u32 m0, s38, 81920
  s_nop 0
  buffer_load_dwordx4 v6, s[16:19], s60 offen lds
  s_mov_b64 exec, -1
  s_add_u32 m0, s38, 50176
  s_add_u32 s60, s52, 524288
  buffer_load_dwordx4 v5, s[8:11], s60 offen lds
  s_add_u32 s60, s53, 14336
  s_mov_b64 exec, s[50:51]
  s_add_u32 m0, s38, 66560
  s_nop 0
  buffer_load_dwordx4 v6, s[12:15], s60 offen lds
  s_add_u32 m0, s38, 82944
  s_nop 0
  buffer_load_dwordx4 v6, s[16:19], s60 offen lds
  s_mov_b64 exec, -1
  s_add_u32 m0, s38, 51200
  s_add_u32 s60, s52, 1048576
  buffer_load_dwordx4 v4, s[8:11], s60 offen lds
  s_add_u32 s60, s53, 28672
  s_mov_b64 exec, s[50:51]
  s_add_u32 m0, s38, 67584
  s_nop 0
  buffer_load_dwordx4 v6, s[12:15], s60 offen lds
  s_add_u32 m0, s38, 83968
  s_nop 0
  buffer_load_dwordx4 v6, s[16:19], s60 offen lds
  s_mov_b64 exec, -1
  s_add_u32 m0, s38, 52224
  s_add_u32 s60, s52, 1572864
  buffer_load_dwordx4 v5, s[8:11], s60 offen lds
  s_add_u32 s60, s53, 43008
  s_mov_b64 exec, s[50:51]
  s_add_u32 m0, s38, 68608
  s_nop 0
  buffer_load_dwordx4 v6, s[12:15], s60 offen lds
  s_add_u32 m0, s38, 84992
  s_nop 0
  buffer_load_dwordx4 v6, s[16:19], s60 offen lds
  s_mov_b64 exec, -1
  s_waitcnt vmcnt(13) lgkmcnt(0)
  s_cmp_lg_u32 s32, 4
  s_cbranch_scc1 p1H_sq
  s_waitcnt vmcnt(12)
  s_add_u32 s62, s4, 0x1000000
  s_addc_u32 s63, s5, 0
  s_mov_b32 s58, 0
  s_mov_b64 exec, 3
  s_branch pk_5
pc_3:
  global_load_dword v24, v23, s[62:63] sc1
  s_waitcnt vmcnt(0)
pk_5:
  v_cmp_ne_u32 vcc, v24, v25
  s_cbranch_vccz pd_4
  s_add_u32 s58, s58, 1
  s_cmp_lt_u32 s58, 8192
  s_cbranch_scc1 pc_3
pd_4:
  s_mov_b64 exec, -1
p1H_sq:
  s_barrier
  v_and_b32 v77, 255, v0
  v_lshrrev_b32 v77, 4, v77
  s_lshl_b32 s60, s35, 7
  v_add_u32 v76, s60, v77
  v_mul_u32_u24 v76, 257, v76
  v_and_b32 v78, 15, v0
  s_lshl_b32 s60, s34, 4
  v_add_u32 v78, s60, v78
  v_add_u32 v76, v76, v78
  v_lshlrev_b32 v76, 1, v76
  s_lshr_b32 s60, s35, 2
  s_lshl_b32 s60, s60, 11
  s_and_b32 s61, s35, 3
  s_lshl_b32 s61, s61, 8
  s_add_u32 s65, s60, s61
  v_lshlrev_b32 v77, 4, v77
  v_add_u32 v77, s65, v77
  v_lshl_add_u32 v77, v78, 13, v77
  s_mov_b32 s42, 0x101000
  s_mov_b32 s43, 0x20000
  s_mov_b32 s46, 0x101000
  s_mov_b32 s47, 0x20000
  s_mov_b32 s60, 0
  buffer_load_short_d16 v128, v76, s[40:43], s60 offen
  buffer_load_short_d16_hi v136, v76, s[44:47], s60 offen
  s_mov_b32 s60, 16448
  buffer_load_short_d16 v129, v76, s[40:43], s60 offen
  buffer_load_short_d16_hi v137, v76, s[44:47], s60 offen
  s_mov_b32 s60, 32896
  buffer_load_short_d16 v130, v76, s[40:43], s60 offen
  buffer_load_short_d16_hi v138, v76, s[44:47], s60 offen
  s_mov_b32 s60, 49344
  buffer_load_short_d16 v131, v76, s[40:43], s60 offen
  buffer_load_short_d16_hi v139, v76, s[44:47], s60 offen
  s_mov_b32 s60, 8224
  buffer_load_short_d16 v132, v76, s[40:43], s60 offen
  buffer_load_short_d16_hi v140, v76, s[44:47], s60 offen
  s_mov_b32 s60, 24672
  buffer_load_short_d16 v133, v76, s[40:43], s60 offen
  buffer_load_short_d16_hi v141, v76, s[44:47], s60 offen
  s_mov_b32 s60, 41120
  buffer_load_short_d16 v134, v76, s[40:43], s60 offen
  buffer_load_short_d16_hi v142, v76, s[44:47], s60 offen
  s_mov_b32 s60, 57568
  buffer_load_short_d16 v135, v76, s[40:43], s60 offen
  buffer_load_short_d16_hi v143, v76, s[44:47], s60 offen
  s_cmp_lg_u32 s34, 0
  s_cbranch_scc1 p1H_wt0
  s_cmp_lg_u32 s32, 4
  s_cbranch_scc1 p1H_wt0
  s_lshl_b32 s60, s35, 7
  v_add_u32 v78, s60, v3
  v_mul_u32_u24 v78, 257, v78
  v_add_u32 v78, 256, v78
  v_lshlrev_b32 v78, 1, v78
  s_mov_b32 s60, 0
  buffer_load_short_d16 v144, v78, s[40:43], s60 offen
  buffer_load_short_d16_hi v148, v78, s[44:47], s60 offen
  s_mov_b32 s60, 16448
  buffer_load_short_d16 v145, v78, s[40:43], s60 offen
  buffer_load_short_d16_hi v149, v78, s[44:47], s60 offen
  s_mov_b32 s60, 32896
  buffer_load_short_d16 v146, v78, s[40:43], s60 offen
  buffer_load_short_d16_hi v150, v78, s[44:47], s60 offen
  s_mov_b32 s60, 49344
  buffer_load_short_d16 v147, v78, s[40:43], s60 offen
  buffer_load_short_d16_hi v151, v78, s[44:47], s60 offen
p1H_wt0:
  s_lshl_b32 s60, s35, 7
  s_lshl_b32 s61, s37, 6
  s_add_u32 s60, s60, s61
  v_add_u32 v104, s60, v3
  v_lshlrev_b32 v105, 3, v104
  s_add_u32 s62, s4, 16875520
  s_addc_u32 s63, s5, 0
  global_load_dwordx2 v[108:109], v105, s[62:63] sc1
  global_load_dwordx2 v[110:111], v105, s[62:63] offset:256 sc1
  s_lshl_b32 s60, s34, 14
  s_add_u32 s60, s60, 17039360
  s_add_u32 s20, s4, s60
  s_addc_u32 s21, s5, 0
  v_and_b32 v22, 255, v0
  v_lshlrev_b32 v22, 2, v22
  global_load_dword v160, v22, s[20:21] offset:0 sc1
  global_load_dword v161, v22, s[20:21] offset:1024 sc1
  global_load_dword v162, v22, s[20:21] offset:2048 sc1
  global_load_dword v163, v22, s[20:21] offset:3072 sc1
  v_add_u32 v22, 4096, v22
  global_load_dword v164, v22, s[20:21] offset:0 sc1
  global_load_dword v165, v22, s[20:21] offset:1024 sc1
  global_load_dword v166, v22, s[20:21] offset:2048 sc1
  global_load_dword v167, v22, s[20:21] offset:3072 sc1
  v_add_u32 v22, 4096, v22
  global_load_dword v168, v22, s[20:21] offset:0 sc1
  global_load_dword v169, v22, s[20:21] offset:1024 sc1
  global_load_dword v170, v22, s[20:21] offset:2048 sc1
  global_load_dword v171, v22, s[20:21] offset:3072 sc1
  v_add_u32 v22, 4096, v22
  global_load_dword v172, v22, s[20:21] offset:0 sc1
  global_load_dword v173, v22, s[20:21] offset:1024 sc1
  global_load_dword v174, v22, s[20:21] offset:2048 sc1
  global_load_dword v175, v22, s[20:21] offset:3072 sc1
  s_waitcnt vmcnt(34) lgkmcnt(0)
  s_barrier
  s_waitcnt vmcnt(0)
  s_add_u32 s40, s4, 0xb40000
  s_addc_u32 s41, s5, 0
  s_mov_b32 s42, 0x202000
  s_mov_b32 s43, 0x20000
  v_or_b32 v128, v128, v136
  v_or_b32 v129, v129, v137
  v_or_b32 v130, v130, v138
  v_or_b32 v131, v131, v139
  buffer_store_dwordx4 v[128:131], v77, s[40:43], 0 offen offset:0 sc1
  v_or_b32 v132, v132, v140
  v_or_b32 v133, v133, v141
  v_or_b32 v134, v134, v142
  v_or_b32 v135, v135, v143
  buffer_store_dwordx4 v[132:135], v77, s[40:43], 0 offen offset:1024 sc1
  s_cmp_lg_u32 s34, 0
  s_cbranch_scc1 p1H_wt1
  s_cmp_lg_u32 s32, 4
  s_cbranch_scc1 p1H_wt1
  v_or_b32 v144, v144, v148
  v_or_b32 v145, v145, v149
  v_or_b32 v146, v146, v150
  v_or_b32 v147, v147, v151
  v_lshrrev_b32 v76, 4, v3
  v_lshlrev_b32 v76, 10, v76
  v_and_b32 v78, 15, v3
  v_lshl_add_u32 v76, v78, 4, v76
  v_add_u32 v76, s65, v76
  v_add_u32 v76, 0x200000, v76
  s_mov_b32 exec_hi, 0
  buffer_store_dwordx4 v[144:147], v76, s[40:43], 0 offen sc1
  s_mov_b64 exec, -1
p1H_wt1:
  v_add_f32 v160, v160, v168
  v_add_f32 v161, v161, v169
  v_add_f32 v162, v162, v170
  v_add_f32 v163, v163, v171
  v_add_f32 v164, v164, v172
  v_add_f32 v165, v165, v173
  v_add_f32 v166, v166, v174
  v_add_f32 v167, v167, v175
  v_add_f32 v160, v160, v164
  v_add_f32 v161, v161, v165
  v_add_f32 v162, v162, v166
  v_add_f32 v163, v163, v167
  v_add_f32 v160, v160, v161
  v_add_f32 v162, v162, v163
  v_add_f32 v160, v160, v162
  v_cvt_pk_bf16_f32 v161, v160, v160
  v_and_b32 v161, 0xffff0000, v161
  v_sub_f32 v162, v160, v161
  v_cvt_pk_bf16_f32 v160, v161, v162
  v_and_b32 v80, 255, v0
  v_lshlrev_b32 v80, 2, v80
  v_add_u32 v80, 162560, v80
  ds_write_b32 v80, v160
  s_lshl_b32 s60, s36, 14
  s_cmp_eq_u32 s36, 3
  s_cselect_b32 s60, 98304, s60
  v_lshlrev_b32 v80, 4, v1
  v_add_u32 v80, s60, v80
  s_waitcnt lgkmcnt(0)
  s_barrier
  ds_read_b128 v[128:131], v80 offset:0
  ds_read_b128 v[132:135], v80 offset:1024
  ds_read_b128 v[136:139], v80 offset:2048
  ds_read_b128 v[140:143], v80 offset:3072
  ds_read_b128 v[144:147], v80 offset:4096
  ds_read_b128 v[148:151], v80 offset:5120
  ds_read_b128 v[152:155], v80 offset:6144
  ds_read_b128 v[156:159], v80 offset:7168
  ds_read_b128 v[160:163], v80 offset:8192
  ds_read_b128 v[164:167], v80 offset:9216
  ds_read_b128 v[168:171], v80 offset:10240
  ds_read_b128 v[172:175], v80 offset:11264
  ds_read_b128 v[176:179], v80 offset:12288
  ds_read_b128 v[180:183], v80 offset:13312
  ds_read_b128 v[184:187], v80 offset:14336
  ds_read_b128 v[188:191], v80 offset:15360
  s_branch p1_join
p1_roleC:
  v_lshrrev_b32 v80, 5, v1
  v_lshlrev_b32 v80, 3, v80
  v_bfe_u32 v81, v1, 2, 2
  v_add_u32 v80, v80, v81
  v_lshlrev_b32 v80, 8, v80
  v_bfe_u32 v82, v1, 4, 1
  v_lshlrev_b32 v82, 1, v82
  v_bfe_u32 v83, v1, 1, 1
  v_add_u32 v82, v82, v83
  s_lshl_b32 s33, s36, 2
  v_add_u32 v82, s33, v82
  v_lshlrev_b32 v81, 2, v81
  v_xor_b32 v82, v82, v81
  v_lshl_add_u32 v80, v82, 4, v80
  v_and_b32 v83, 1, v1
  v_lshl_add_u32 v80, v83, 3, v80
  v_add_u32 v8, 16384, v80
  v_add_u32 v9, 65536, v80
  v_add_u32 v10, 114688, v80
  v_lshlrev_b32 v80, 7, v3
  v_bfe_u32 v81, v3, 1, 3
  v_xor_b32 v81, v81, v2
  v_lshl_add_u32 v80, v81, 4, v80
  v_mov_b32 v28, 0x3f803f80
  v_add_u32 v12, 0, v80
  v_xor_b32 v13, 32, v12
  v_xor_b32 v14, 64, v12
  v_xor_b32 v15, 96, v12
  v_add_u32 v16, 49152, v80
  v_xor_b32 v17, 32, v16
  v_xor_b32 v18, 64, v16
  v_xor_b32 v19, 96, v16
  v_add_u32 v20, 98304, v80
  v_xor_b32 v21, 32, v20
  v_xor_b32 v22, 64, v20
  v_xor_b32 v23, 96, v20
  v_mov_b32 v24, 0
  v_mov_b32 v25, 0
  v_mov_b32 v26, 0
  v_mov_b32 v27, 0
  v_mov_b32 v80, 163584
  v_lshl_add_u32 v80, v1, 2, v80
  v_mov_b32 v81, 0
  ds_write_b32 v80, v81
  s_lshl_b32 s60, s36, 4
  v_and_b32 v80, 15, v1
  v_add_u32 v80, s60, v80
  s_lshl_b32 s60, s49, 6
  v_lshlrev_b32 v81, 6, v2
  v_add_u32 v81, v81, v80
  v_add_u32 v81, s60, v81
  v_and_b32 v81, 511, v81
  v_cvt_f32_u32 v82, v81
  v_mul_f32 v82, 0x3b000000, v82
  v_bfe_u32 v83, v1, 4, 1
  s_lshl_b32 s60, s34, 4
  v_lshlrev_b32 v84, 3, v83
  v_add_u32 v84, s60, v84
  v_cvt_f32_u32 v85, v84
  v_mul_f32 v85, v85, v82
  v_cos_f32 v86, v85
  v_sin_f32 v88, v85
  v_add_f32 v85, v85, v82
  v_cos_f32 v87, v85
  v_sin_f32 v89, v85
  v_add_f32 v85, v85, v82
  v_cvt_pk_bf16_f32 v32, v86, v87
  v_cvt_pk_bf16_f32 v36, -v88, -v89
  v_cos_f32 v86, v85
  v_sin_f32 v88, v85
  v_add_f32 v85, v85, v82
  v_cos_f32 v87, v85
  v_sin_f32 v89, v85
  v_add_f32 v85, v85, v82
  v_cvt_pk_bf16_f32 v33, v86, v87
  v_cvt_pk_bf16_f32 v37, -v88, -v89
  v_cos_f32 v86, v85
  v_sin_f32 v88, v85
  v_add_f32 v85, v85, v82
  v_cos_f32 v87, v85
  v_sin_f32 v89, v85
  v_add_f32 v85, v85, v82
  v_cvt_pk_bf16_f32 v34, v86, v87
  v_cvt_pk_bf16_f32 v38, -v88, -v89
  v_cos_f32 v86, v85
  v_sin_f32 v88, v85
  v_add_f32 v85, v85, v82
  v_cos_f32 v87, v85
  v_sin_f32 v89, v85
  v_add_f32 v85, v85, v82
  v_cvt_pk_bf16_f32 v35, v86, v87
  v_cvt_pk_bf16_f32 v39, -v88, -v89
  v_and_b32 v86, 1, v80
  v_lshlrev_b32 v86, 15, v86
  v_or_b32 v86, 0x3f80, v86
  v_mov_b32 v87, 0xffff
  v_bfi_b32 v86, v87, v86, v36
  v_cmp_eq_u32 vcc, 0, v84
  s_nop 1
  v_cndmask_b32 v36, v36, v86, vcc
  v_and_b32 v86, 3, v80
  v_lshlrev_b32 v86, 2, v86
  v_add_u32 v87, 14, v83
  v_xor_b32 v86, v86, v87
  v_lshlrev_b32 v86, 4, v86
  v_lshl_add_u32 v86, v80, 8, v86
  v_mul_u32_u24 v87, 49152, v2
  v_add_u32 v86, v86, v87
  v_add_u32 v86, 16384, v86
  ds_write_b128 v86, v[32:35]
  ds_write_b128 v86, v[36:39] offset:16384
  s_waitcnt lgkmcnt(0)
  s_barrier
  ds_read_b64_tr_b16 v[32:33], v8 offset:0
  ds_read_b64_tr_b16 v[34:35], v8 offset:1024
  ds_read_b128 v[48:51], v12 offset:0
  ds_read_b64_tr_b16 v[36:37], v8 offset:16384
  ds_read_b64_tr_b16 v[38:39], v8 offset:17408
  ds_read_b128 v[52:55], v12 offset:4096
  ds_read_b128 v[56:59], v12 offset:8192
  ds_read_b128 v[60:63], v12 offset:12288
  ds_read_b64_tr_b16 v[40:41], v8 offset:4096
  ds_read_b64_tr_b16 v[42:43], v8 offset:5120
  ds_read_b128 v[64:67], v13 offset:0
  ds_read_b64_tr_b16 v[44:45], v8 offset:20480
  ds_read_b64_tr_b16 v[46:47], v8 offset:21504
  ds_read_b128 v[68:71], v13 offset:4096
  ds_read_b128 v[72:75], v13 offset:8192
  ds_read_b128 v[76:79], v13 offset:12288
  s_waitcnt lgkmcnt(13)
  v_mfma_f32_32x32x16_bf16 v[128:143], v[32:35], v[48:51], 0
  ds_read_b64_tr_b16 v[80:81], v8 offset:8192
  ds_read_b64_tr_b16 v[82:83], v8 offset:9216
  v_dot2c_f32_bf16 v24, v32, v28
  s_waitcnt lgkmcnt(13)
  v_mfma_f32_32x32x16_bf16 v[160:175], v[36:39], v[48:51], 0
  ds_read_b128 v[88:91], v14 offset:0
  v_dot2c_f32_bf16 v24, v33, v28
  s_waitcnt lgkmcnt(13)
  v_mfma_f32_32x32x16_bf16 v[144:159], v[32:35], v[52:55], 0
  ds_read_b64_tr_b16 v[84:85], v8 offset:24576
  ds_read_b64_tr_b16 v[86:87], v8 offset:25600
  v_dot2c_f32_bf16 v24, v34, v28
  v_mfma_f32_32x32x16_bf16 v[176:191], v[36:39], v[52:55], 0
  ds_read_b128 v[92:95], v14 offset:4096
  v_dot2c_f32_bf16 v24, v35, v28
  s_waitcnt lgkmcnt(15)
  v_mfma_f32_32x32x16_bf16 v[192:207], v[32:35], v[56:59], 0
  ds_read_b128 v[96:99], v14 offset:8192
  v_dot2c_f32_bf16 v25, v36, v28
  v_mfma_f32_32x32x16_bf16 v[224:239], v[36:39], v[56:59], 0
  ds_read_b128 v[100:103], v14 offset:12288
  v_dot2c_f32_bf16 v25, v37, v28
  s_waitcnt lgkmcnt(15)
  v_mfma_f32_32x32x16_bf16 v[208:223], v[32:35], v[60:63], 0
  v_dot2c_f32_bf16 v25, v38, v28
  v_mfma_f32_32x32x16_bf16 v[240:255], v[36:39], v[60:63], 0
  v_dot2c_f32_bf16 v25, v39, v28
  s_waitcnt lgkmcnt(13)
  v_mfma_f32_32x32x16_bf16 v[128:143], v[40:43], v[64:67], v[128:143]
  ds_read_b64_tr_b16 v[32:33], v8 offset:12288
  ds_read_b64_tr_b16 v[34:35], v8 offset:13312
  v_dot2c_f32_bf16 v24, v40, v28
  s_waitcnt lgkmcnt(13)
  v_mfma_f32_32x32x16_bf16 v[160:175], v[44:47], v[64:67], v[160:175]
  ds_read_b128 v[48:51], v15 offset:0
  v_dot2c_f32_bf16 v24, v41, v28
  s_waitcnt lgkmcnt(13)
  v_mfma_f32_32x32x16_bf16 v[144:159], v[40:43], v[68:71], v[144:159]
  ds_read_b64_tr_b16 v[36:37], v8 offset:28672
  ds_read_b64_tr_b16 v[38:39], v8 offset:29696
  v_dot2c_f32_bf16 v24, v42, v28
  v_mfma_f32_32x32x16_bf16 v[176:191], v[44:47], v[68:71], v[176:191]
  ds_read_b128 v[52:55], v15 offset:4096
  v_dot2c_f32_bf16 v24, v43, v28
  s_waitcnt lgkmcnt(15)
  v_mfma_f32_32x32x16_bf16 v[192:207], v[40:43], v[72:75], v[192:207]
  ds_read_b128 v[56:59], v15 offset:8192
  v_dot2c_f32_bf16 v25, v44, v28
  v_mfma_f32_32x32x16_bf16 v[224:239], v[44:47], v[72:75], v[224:239]
  ds_read_b128 v[60:63], v15 offset:12288
  v_dot2c_f32_bf16 v25, v45, v28
  s_waitcnt lgkmcnt(15)
  v_mfma_f32_32x32x16_bf16 v[208:223], v[40:43], v[76:79], v[208:223]
  v_dot2c_f32_bf16 v25, v46, v28
  v_mfma_f32_32x32x16_bf16 v[240:255], v[44:47], v[76:79], v[240:255]
  v_dot2c_f32_bf16 v25, v47, v28
  s_waitcnt lgkmcnt(13)
  v_mfma_f32_32x32x16_bf16 v[128:143], v[80:83], v[88:91], v[128:143]
  v_dot2c_f32_bf16 v26, v80, v28
  s_waitcnt lgkmcnt(11)
  v_mfma_f32_32x32x16_bf16 v[160:175], v[84:87], v[88:91], v[160:175]
  v_dot2c_f32_bf16 v26, v81, v28
  s_waitcnt lgkmcnt(10)
  v_mfma_f32_32x32x16_bf16 v[144:159], v[80:83], v[92:95], v[144:159]
  v_dot2c_f32_bf16 v26, v82, v28
  v_mfma_f32_32x32x16_bf16 v[176:191], v[84:87], v[92:95], v[176:191]
  v_dot2c_f32_bf16 v26, v83, v28
  s_waitcnt lgkmcnt(9)
  v_mfma_f32_32x32x16_bf16 v[192:207], v[80:83], v[96:99], v[192:207]
  v_dot2c_f32_bf16 v27, v84, v28
  v_mfma_f32_32x32x16_bf16 v[224:239], v[84:87], v[96:99], v[224:239]
  v_dot2c_f32_bf16 v27, v85, v28
  s_waitcnt lgkmcnt(8)
  v_mfma_f32_32x32x16_bf16 v[208:223], v[80:83], v[100:103], v[208:223]
  v_dot2c_f32_bf16 v27, v86, v28
  v_mfma_f32_32x32x16_bf16 v[240:255], v[84:87], v[100:103], v[240:255]
  v_dot2c_f32_bf16 v27, v87, v28
  s_waitcnt lgkmcnt(0)
  s_barrier
  v_mfma_f32_32x32x16_bf16 v[128:143], v[32:35], v[48:51], v[128:143]
  ds_read_b64_tr_b16 v[40:41], v9 offset:0
  ds_read_b64_tr_b16 v[42:43], v9 offset:1024
  ds_read_b128 v[64:67], v16 offset:0
  v_dot2c_f32_bf16 v26, v32, v28
  v_mfma_f32_32x32x16_bf16 v[160:175], v[36:39], v[48:51], v[160:175]
  ds_read_b64_tr_b16 v[44:45], v9 offset:16384
  ds_read_b64_tr_b16 v[46:47], v9 offset:17408
  v_dot2c_f32_bf16 v26, v33, v28
  v_mfma_f32_32x32x16_bf16 v[144:159], v[32:35], v[52:55], v[144:159]
  ds_read_b128 v[68:71], v16 offset:4096
  ds_read_b128 v[72:75], v16 offset:8192
  v_dot2c_f32_bf16 v26, v34, v28
  v_mfma_f32_32x32x16_bf16 v[176:191], v[36:39], v[52:55], v[176:191]
  ds_read_b128 v[76:79], v16 offset:12288
  v_dot2c_f32_bf16 v26, v35, v28
  v_mfma_f32_32x32x16_bf16 v[192:207], v[32:35], v[56:59], v[192:207]
  ds_read_b64_tr_b16 v[80:81], v9 offset:4096
  ds_read_b64_tr_b16 v[82:83], v9 offset:5120
  ds_read_b128 v[88:91], v17 offset:0
  v_dot2c_f32_bf16 v27, v36, v28
  v_mfma_f32_32x32x16_bf16 v[224:239], v[36:39], v[56:59], v[224:239]
  ds_read_b64_tr_b16 v[84:85], v9 offset:20480
  ds_read_b64_tr_b16 v[86:87], v9 offset:21504
  v_dot2c_f32_bf16 v27, v37, v28
  v_mfma_f32_32x32x16_bf16 v[208:223], v[32:35], v[60:63], v[208:223]
  ds_read_b128 v[92:95], v17 offset:4096
  ds_read_b128 v[96:99], v17 offset:8192
  v_dot2c_f32_bf16 v27, v38, v28
  v_mfma_f32_32x32x16_bf16 v[240:255], v[36:39], v[60:63], v[240:255]
  ds_read_b128 v[100:103], v17 offset:12288
  v_dot2c_f32_bf16 v27, v39, v28
  s_waitcnt lgkmcnt(13)
  v_mfma_f32_32x32x16_bf16 v[128:143], v[40:43], v[64:67], v[128:143]
  ds_read_b64_tr_b16 v[32:33], v9 offset:8192
  ds_read_b64_tr_b16 v[34:35], v9 offset:9216
  s_waitcnt lgkmcnt(13)
  v_mfma_f32_32x32x16_bf16 v[160:175], v[44:47], v[64:67], v[160:175]
  ds_read_b128 v[48:51], v18 offset:0
  s_bitcmp1_b32 s35, 0
  s_cselect_b64 vcc, -1, 0
  v_cndmask_b32 v104, v24, v26, vcc
  v_cndmask_b32 v106, v25, v27, vcc
  s_waitcnt lgkmcnt(13)
  v_mfma_f32_32x32x16_bf16 v[144:159], v[40:43], v[68:71], v[144:159]
  ds_read_b64_tr_b16 v[36:37], v9 offset:24576
  ds_read_b64_tr_b16 v[38:39], v9 offset:25600
  v_mov_b32 v105, v104
  v_mov_b32 v107, v106
  s_lshl_b32 s60, s34, 4
  s_add_u32 s60, s60, s35
  v_mfma_f32_32x32x16_bf16 v[176:191], v[44:47], v[68:71], v[176:191]
  ds_read_b128 v[52:55], v18 offset:4096
  v_permlane32_swap_b32 v104, v105
  v_permlane32_swap_b32 v106, v107
  s_lshl_b32 s60, s60, 10
  s_lshl_b32 s61, s36, 7
  s_waitcnt lgkmcnt(15)
  v_mfma_f32_32x32x16_bf16 v[192:207], v[40:43], v[72:75], v[192:207]
  ds_read_b128 v[56:59], v18 offset:8192
  v_add_f32 v104, v104, v105
  v_add_f32 v106, v106, v107
  s_add_u32 s60, s60, s61
  s_add_u32 s60, s60, 17039360
  v_mfma_f32_32x32x16_bf16 v[224:239], v[44:47], v[72:75], v[224:239]
  ds_read_b128 v[60:63], v18 offset:12288
  s_waitcnt lgkmcnt(15)
  v_mfma_f32_32x32x16_bf16 v[208:223], v[40:43], v[76:79], v[208:223]
  s_add_u32 s62, s4, s60
  s_addc_u32 s63, s5, 0
  v_lshlrev_b32 v105, 2, v3
  s_mov_b32 exec_hi, 0
  global_store_dword v105, v104, s[62:63] sc1
  s_mov_b64 exec, -1
  v_mfma_f32_32x32x16_bf16 v[240:255], v[44:47], v[76:79], v[240:255]
  s_mov_b32 exec_hi, 0
  global_store_dword v105, v106, s[62:63] offset:512 sc1
  s_mov_b64 exec, -1
  s_waitcnt lgkmcnt(13)
  v_mfma_f32_32x32x16_bf16 v[128:143], v[80:83], v[88:91], v[128:143]
  ds_read_b64_tr_b16 v[40:41], v9 offset:12288
  ds_read_b64_tr_b16 v[42:43], v9 offset:13312
  s_waitcnt lgkmcnt(13)
  v_mfma_f32_32x32x16_bf16 v[160:175], v[84:87], v[88:91], v[160:175]
  ds_read_b128 v[64:67], v19 offset:0
  s_waitcnt lgkmcnt(13)
  v_mfma_f32_32x32x16_bf16 v[144:159], v[80:83], v[92:95], v[144:159]
  ds_read_b64_tr_b16 v[44:45], v9 offset:28672
  ds_read_b64_tr_b16 v[46:47], v9 offset:29696
  v_mfma_f32_32x32x16_bf16 v[176:191], v[84:87], v[92:95], v[176:191]
  ds_read_b128 v[68:71], v19 offset:4096
  s_waitcnt lgkmcnt(15)
  v_mfma_f32_32x32x16_bf16 v[192:207], v[80:83], v[96:99], v[192:207]
  ds_read_b128 v[72:75], v19 offset:8192
  v_mfma_f32_32x32x16_bf16 v[224:239], v[84:87], v[96:99], v[224:239]
  ds_read_b128 v[76:79], v19 offset:12288
  s_waitcnt lgkmcnt(15)
  v_mfma_f32_32x32x16_bf16 v[208:223], v[80:83], v[100:103], v[208:223]
  v_mfma_f32_32x32x16_bf16 v[240:255], v[84:87], v[100:103], v[240:255]
  s_waitcnt lgkmcnt(13)
  v_mfma_f32_32x32x16_bf16 v[128:143], v[32:35], v[48:51], v[128:143]
  s_waitcnt lgkmcnt(11)
  v_mfma_f32_32x32x16_bf16 v[160:175], v[36:39], v[48:51], v[160:175]
  s_waitcnt lgkmcnt(10)
  v_mfma_f32_32x32x16_bf16 v[144:159], v[32:35], v[52:55], v[144:159]
  v_mfma_f32_32x32x16_bf16 v[176:191], v[36:39], v[52:55], v[176:191]
  s_waitcnt lgkmcnt(9)
  v_mfma_f32_32x32x16_bf16 v[192:207], v[32:35], v[56:59], v[192:207]
  v_mfma_f32_32x32x16_bf16 v[224:239], v[36:39], v[56:59], v[224:239]
  s_waitcnt lgkmcnt(8)
  v_mfma_f32_32x32x16_bf16 v[208:223], v[32:35], v[60:63], v[208:223]
  v_mfma_f32_32x32x16_bf16 v[240:255], v[36:39], v[60:63], v[240:255]
  s_waitcnt lgkmcnt(0)
  s_barrier
  v_mfma_f32_32x32x16_bf16 v[128:143], v[40:43], v[64:67], v[128:143]
  ds_read_b64_tr_b16 v[80:81], v10 offset:0
  ds_read_b64_tr_b16 v[82:83], v10 offset:1024
  ds_read_b128 v[88:91], v20 offset:0
  v_mfma_f32_32x32x16_bf16 v[160:175], v[44:47], v[64:67], v[160:175]
  ds_read_b64_tr_b16 v[84:85], v10 offset:16384
  ds_read_b64_tr_b16 v[86:87], v10 offset:17408
  v_mfma_f32_32x32x16_bf16 v[144:159], v[40:43], v[68:71], v[144:159]
  ds_read_b128 v[92:95], v20 offset:4096
  ds_read_b128 v[96:99], v20 offset:8192
  v_mfma_f32_32x32x16_bf16 v[176:191], v[44:47], v[68:71], v[176:191]
  ds_read_b128 v[100:103], v20 offset:12288
  v_mfma_f32_32x32x16_bf16 v[192:207], v[40:43], v[72:75], v[192:207]
  ds_read_b64_tr_b16 v[32:33], v10 offset:4096
  ds_read_b64_tr_b16 v[34:35], v10 offset:5120
  ds_read_b128 v[48:51], v21 offset:0
  v_mfma_f32_32x32x16_bf16 v[224:239], v[44:47], v[72:75], v[224:239]
  ds_read_b64_tr_b16 v[36:37], v10 offset:20480
  ds_read_b64_tr_b16 v[38:39], v10 offset:21504
  v_mfma_f32_32x32x16_bf16 v[208:223], v[40:43], v[76:79], v[208:223]
  ds_read_b128 v[52:55], v21 offset:4096
  ds_read_b128 v[56:59], v21 offset:8192
  v_mfma_f32_32x32x16_bf16 v[240:255], v[44:47], v[76:79], v[240:255]
  ds_read_b128 v[60:63], v21 offset:12288
  s_waitcnt lgkmcnt(13)
  v_mfma_f32_32x32x16_bf16 v[128:143], v[80:83], v[88:91], v[128:143]
  ds_read_b64_tr_b16 v[40:41], v10 offset:8192
  ds_read_b64_tr_b16 v[42:43], v10 offset:9216
  s_waitcnt lgkmcnt(13)
  v_mfma_f32_32x32x16_bf16 v[160:175], v[84:87], v[88:91], v[160:175]
  ds_read_b128 v[64:67], v22 offset:0
  s_waitcnt lgkmcnt(13)
  v_mfma_f32_32x32x16_bf16 v[144:159], v[80:83], v[92:95], v[144:159]
  ds_read_b64_tr_b16 v[44:45], v10 offset:24576
  ds_read_b64_tr_b16 v[46:47], v10 offset:25600
  v_mfma_f32_32x32x16_bf16 v[176:191], v[84:87], v[92:95], v[176:191]
  ds_read_b128 v[68:71], v22 offset:4096
  s_waitcnt lgkmcnt(15)
  v_mfma_f32_32x32x16_bf16 v[192:207], v[80:83], v[96:99], v[192:207]
  ds_read_b128 v[72:75], v22 offset:8192
  v_mfma_f32_32x32x16_bf16 v[224:239], v[84:87], v[96:99], v[224:239]
  ds_read_b128 v[76:79], v22 offset:12288
  s_waitcnt lgkmcnt(15)
  v_mfma_f32_32x32x16_bf16 v[208:223], v[80:83], v[100:103], v[208:223]
  v_mfma_f32_32x32x16_bf16 v[240:255], v[84:87], v[100:103], v[240:255]
  s_waitcnt lgkmcnt(13)
  v_mfma_f32_32x32x16_bf16 v[128:143], v[32:35], v[48:51], v[128:143]
  ds_read_b64_tr_b16 v[80:81], v10 offset:12288
  ds_read_b64_tr_b16 v[82:83], v10 offset:13312
  s_waitcnt lgkmcnt(13)
  v_mfma_f32_32x32x16_bf16 v[160:175], v[36:39], v[48:51], v[160:175]
  ds_read_b128 v[88:91], v23 offset:0
  s_waitcnt lgkmcnt(13)
  v_mfma_f32_32x32x16_bf16 v[144:159], v[32:35], v[52:55], v[144:159]
  ds_read_b64_tr_b16 v[84:85], v10 offset:28672
  ds_read_b64_tr_b16 v[86:87], v10 offset:29696
  v_mfma_f32_32x32x16_bf16 v[176:191], v[36:39], v[52:55], v[176:191]
  ds_read_b128 v[92:95], v23 offset:4096
  s_waitcnt lgkmcnt(15)
  v_mfma_f32_32x32x16_bf16 v[192:207], v[32:35], v[56:59], v[192:207]
  ds_read_b128 v[96:99], v23 offset:8192
  v_mfma_f32_32x32x16_bf16 v[224:239], v[36:39], v[56:59], v[224:239]
  ds_read_b128 v[100:103], v23 offset:12288
  s_waitcnt lgkmcnt(15)
  v_mfma_f32_32x32x16_bf16 v[208:223], v[32:35], v[60:63], v[208:223]
  v_mfma_f32_32x32x16_bf16 v[240:255], v[36:39], v[60:63], v[240:255]
  s_waitcnt lgkmcnt(13)
  v_mfma_f32_32x32x16_bf16 v[128:143], v[40:43], v[64:67], v[128:143]
  s_waitcnt lgkmcnt(11)
  v_mfma_f32_32x32x16_bf16 v[160:175], v[44:47], v[64:67], v[160:175]
  s_waitcnt lgkmcnt(10)
  v_mfma_f32_32x32x16_bf16 v[144:159], v[40:43], v[68:71], v[144:159]
  v_mfma_f32_32x32x16_bf16 v[176:191], v[44:47], v[68:71], v[176:191]
  s_waitcnt lgkmcnt(9)
  v_mfma_f32_32x32x16_bf16 v[192:207], v[40:43], v[72:75], v[192:207]
  v_mfma_f32_32x32x16_bf16 v[224:239], v[44:47], v[72:75], v[224:239]
  s_waitcnt lgkmcnt(8)
  v_mfma_f32_32x32x16_bf16 v[208:223], v[40:43], v[76:79], v[208:223]
  v_mfma_f32_32x32x16_bf16 v[240:255], v[44:47], v[76:79], v[240:255]
  s_waitcnt vmcnt(0)
  s_waitcnt lgkmcnt(0)
  s_barrier
  v_mfma_f32_32x32x16_bf16 v[128:143], v[80:83], v[88:91], v[128:143]
  ds_read_b64_tr_b16 v[32:33], v8 offset:0
  ds_read_b64_tr_b16 v[34:35], v8 offset:1024
  ds_read_b128 v[48:51], v12 offset:0
  v_mfma_f32_32x32x16_bf16 v[160:175], v[84:87], v[88:91], v[160:175]
  ds_read_b64_tr_b16 v[36:37], v8 offset:16384
  ds_read_b64_tr_b16 v[38:39], v8 offset:17408
  v_mfma_f32_32x32x16_bf16 v[144:159], v[80:83], v[92:95], v[144:159]
  ds_read_b128 v[52:55], v12 offset:4096
  ds_read_b128 v[56:59], v12 offset:8192
  v_mfma_f32_32x32x16_bf16 v[176:191], v[84:87], v[92:95], v[176:191]
  ds_read_b128 v[60:63], v12 offset:12288
  v_mfma_f32_32x32x16_bf16 v[192:207], v[80:83], v[96:99], v[192:207]
  ds_read_b64_tr_b16 v[40:41], v8 offset:4096
  ds_read_b64_tr_b16 v[42:43], v8 offset:5120
  ds_read_b128 v[64:67], v13 offset:0
  v_mfma_f32_32x32x16_bf16 v[224:239], v[84:87], v[96:99], v[224:239]
  ds_read_b64_tr_b16 v[44:45], v8 offset:20480
  ds_read_b64_tr_b16 v[46:47], v8 offset:21504
  v_mfma_f32_32x32x16_bf16 v[208:223], v[80:83], v[100:103], v[208:223]
  ds_read_b128 v[68:71], v13 offset:4096
  ds_read_b128 v[72:75], v13 offset:8192
  v_mfma_f32_32x32x16_bf16 v[240:255], v[84:87], v[100:103], v[240:255]
  ds_read_b128 v[76:79], v13 offset:12288
  s_waitcnt lgkmcnt(13)
  v_mfma_f32_32x32x16_bf16 v[128:143], v[32:35], v[48:51], v[128:143]
  ds_read_b64_tr_b16 v[80:81], v8 offset:8192
  ds_read_b64_tr_b16 v[82:83], v8 offset:9216
  s_waitcnt lgkmcnt(13)
  v_mfma_f32_32x32x16_bf16 v[160:175], v[36:39], v[48:51], v[160:175]
  ds_read_b128 v[88:91], v14 offset:0
  s_waitcnt lgkmcnt(13)
  v_mfma_f32_32x32x16_bf16 v[144:159], v[32:35], v[52:55], v[144:159]
  ds_read_b64_tr_b16 v[84:85], v8 offset:24576
  ds_read_b64_tr_b16 v[86:87], v8 offset:25600
  v_mfma_f32_32x32x16_bf16 v[176:191], v[36:39], v[52:55], v[176:191]
  ds_read_b128 v[92:95], v14 offset:4096
  s_waitcnt lgkmcnt(15)
  v_mfma_f32_32x32x16_bf16 v[192:207], v[32:35], v[56:59], v[192:207]
  ds_read_b128 v[96:99], v14 offset:8192
  v_mfma_f32_32x32x16_bf16 v[224:239], v[36:39], v[56:59], v[224:239]
  ds_read_b128 v[100:103], v14 offset:12288
  s_waitcnt lgkmcnt(15)
  v_mfma_f32_32x32x16_bf16 v[208:223], v[32:35], v[60:63], v[208:223]
  v_mfma_f32_32x32x16_bf16 v[240:255], v[36:39], v[60:63], v[240:255]
  s_waitcnt lgkmcnt(13)
  v_mfma_f32_32x32x16_bf16 v[128:143], v[40:43], v[64:67], v[128:143]
  ds_read_b64_tr_b16 v[32:33], v8 offset:12288
  ds_read_b64_tr_b16 v[34:35], v8 offset:13312
  s_waitcnt lgkmcnt(13)
  v_mfma_f32_32x32x16_bf16 v[160:175], v[44:47], v[64:67], v[160:175]
  ds_read_b128 v[48:51], v15 offset:0
  s_waitcnt lgkmcnt(13)
  v_mfma_f32_32x32x16_bf16 v[144:159], v[40:43], v[68:71], v[144:159]
  ds_read_b64_tr_b16 v[36:37], v8 offset:28672
  ds_read_b64_tr_b16 v[38:39], v8 offset:29696
  v_mfma_f32_32x32x16_bf16 v[176:191], v[44:47], v[68:71], v[176:191]
  ds_read_b128 v[52:55], v15 offset:4096
  s_waitcnt lgkmcnt(15)
  v_mfma_f32_32x32x16_bf16 v[192:207], v[40:43], v[72:75], v[192:207]
  ds_read_b128 v[56:59], v15 offset:8192
  v_mfma_f32_32x32x16_bf16 v[224:239], v[44:47], v[72:75], v[224:239]
  ds_read_b128 v[60:63], v15 offset:12288
  s_waitcnt lgkmcnt(15)
  v_mfma_f32_32x32x16_bf16 v[208:223], v[40:43], v[76:79], v[208:223]
  v_mfma_f32_32x32x16_bf16 v[240:255], v[44:47], v[76:79], v[240:255]
  s_waitcnt lgkmcnt(13)
  v_mfma_f32_32x32x16_bf16 v[128:143], v[80:83], v[88:91], v[128:143]
  s_waitcnt lgkmcnt(11)
  v_mfma_f32_32x32x16_bf16 v[160:175], v[84:87], v[88:91], v[160:175]
  s_waitcnt lgkmcnt(10)
  v_mfma_f32_32x32x16_bf16 v[144:159], v[80:83], v[92:95], v[144:159]
  v_mfma_f32_32x32x16_bf16 v[176:191], v[84:87], v[92:95], v[176:191]
  s_waitcnt lgkmcnt(9)
  v_mfma_f32_32x32x16_bf16 v[192:207], v[80:83], v[96:99], v[192:207]
  v_mfma_f32_32x32x16_bf16 v[224:239], v[84:87], v[96:99], v[224:239]
  s_waitcnt lgkmcnt(8)
  v_mfma_f32_32x32x16_bf16 v[208:223], v[80:83], v[100:103], v[208:223]
  v_mfma_f32_32x32x16_bf16 v[240:255], v[84:87], v[100:103], v[240:255]
  s_waitcnt lgkmcnt(0)
  s_barrier
  v_mfma_f32_32x32x16_bf16 v[128:143], v[32:35], v[48:51], v[128:143]
  ds_read_b64_tr_b16 v[40:41], v9 offset:0
  ds_read_b64_tr_b16 v[42:43], v9 offset:1024
  ds_read_b128 v[64:67], v16 offset:0
  v_mfma_f32_32x32x16_bf16 v[160:175], v[36:39], v[48:51], v[160:175]
  ds_read_b64_tr_b16 v[44:45], v9 offset:16384
  ds_read_b64_tr_b16 v[46:47], v9 offset:17408
  v_mfma_f32_32x32x16_bf16 v[144:159], v[32:35], v[52:55], v[144:159]
  ds_read_b128 v[68:71], v16 offset:4096
  ds_read_b128 v[72:75], v16 offset:8192
  v_mfma_f32_32x32x16_bf16 v[176:191], v[36:39], v[52:55], v[176:191]
  ds_read_b128 v[76:79], v16 offset:12288
  v_mfma_f32_32x32x16_bf16 v[192:207], v[32:35], v[56:59], v[192:207]
  ds_read_b64_tr_b16 v[80:81], v9 offset:4096
  ds_read_b64_tr_b16 v[82:83], v9 offset:5120
  ds_read_b128 v[88:91], v17 offset:0
  v_mfma_f32_32x32x16_bf16 v[224:239], v[36:39], v[56:59], v[224:239]
  ds_read_b64_tr_b16 v[84:85], v9 offset:20480
  ds_read_b64_tr_b16 v[86:87], v9 offset:21504
  v_mfma_f32_32x32x16_bf16 v[208:223], v[32:35], v[60:63], v[208:223]
  ds_read_b128 v[92:95], v17 offset:4096
  ds_read_b128 v[96:99], v17 offset:8192
  v_mfma_f32_32x32x16_bf16 v[240:255], v[36:39], v[60:63], v[240:255]
  ds_read_b128 v[100:103], v17 offset:12288
  s_waitcnt lgkmcnt(13)
  v_mfma_f32_32x32x16_bf16 v[128:143], v[40:43], v[64:67], v[128:143]
  ds_read_b64_tr_b16 v[32:33], v9 offset:8192
  ds_read_b64_tr_b16 v[34:35], v9 offset:9216
  s_waitcnt lgkmcnt(13)
  v_mfma_f32_32x32x16_bf16 v[160:175], v[44:47], v[64:67], v[160:175]
  ds_read_b128 v[48:51], v18 offset:0
  s_waitcnt lgkmcnt(13)
  v_mfma_f32_32x32x16_bf16 v[144:159], v[40:43], v[68:71], v[144:159]
  ds_read_b64_tr_b16 v[36:37], v9 offset:24576
  ds_read_b64_tr_b16 v[38:39], v9 offset:25600
  v_mfma_f32_32x32x16_bf16 v[176:191], v[44:47], v[68:71], v[176:191]
  ds_read_b128 v[52:55], v18 offset:4096
  s_waitcnt lgkmcnt(15)
  v_mfma_f32_32x32x16_bf16 v[192:207], v[40:43], v[72:75], v[192:207]
  ds_read_b128 v[56:59], v18 offset:8192
  v_mfma_f32_32x32x16_bf16 v[224:239], v[44:47], v[72:75], v[224:239]
  ds_read_b128 v[60:63], v18 offset:12288
  s_waitcnt lgkmcnt(15)
  v_mfma_f32_32x32x16_bf16 v[208:223], v[40:43], v[76:79], v[208:223]
  v_mfma_f32_32x32x16_bf16 v[240:255], v[44:47], v[76:79], v[240:255]
  s_waitcnt lgkmcnt(13)
  v_mfma_f32_32x32x16_bf16 v[128:143], v[80:83], v[88:91], v[128:143]
  ds_read_b64_tr_b16 v[40:41], v9 offset:12288
  ds_read_b64_tr_b16 v[42:43], v9 offset:13312
  s_waitcnt lgkmcnt(13)
  v_mfma_f32_32x32x16_bf16 v[160:175], v[84:87], v[88:91], v[160:175]
  ds_read_b128 v[64:67], v19 offset:0
  s_waitcnt lgkmcnt(13)
  v_mfma_f32_32x32x16_bf16 v[144:159], v[80:83], v[92:95], v[144:159]
  ds_read_b64_tr_b16 v[44:45], v9 offset:28672
  ds_read_b64_tr_b16 v[46:47], v9 offset:29696
  v_mfma_f32_32x32x16_bf16 v[176:191], v[84:87], v[92:95], v[176:191]
  ds_read_b128 v[68:71], v19 offset:4096
  s_waitcnt lgkmcnt(15)
  v_mfma_f32_32x32x16_bf16 v[192:207], v[80:83], v[96:99], v[192:207]
  ds_read_b128 v[72:75], v19 offset:8192
  v_mfma_f32_32x32x16_bf16 v[224:239], v[84:87], v[96:99], v[224:239]
  ds_read_b128 v[76:79], v19 offset:12288
  s_waitcnt lgkmcnt(15)
  v_mfma_f32_32x32x16_bf16 v[208:223], v[80:83], v[100:103], v[208:223]
  v_mfma_f32_32x32x16_bf16 v[240:255], v[84:87], v[100:103], v[240:255]
  s_waitcnt lgkmcnt(13)
  v_mfma_f32_32x32x16_bf16 v[128:143], v[32:35], v[48:51], v[128:143]
  s_waitcnt lgkmcnt(11)
  v_mfma_f32_32x32x16_bf16 v[160:175], v[36:39], v[48:51], v[160:175]
  s_waitcnt lgkmcnt(10)
  v_mfma_f32_32x32x16_bf16 v[144:159], v[32:35], v[52:55], v[144:159]
  v_mfma_f32_32x32x16_bf16 v[176:191], v[36:39], v[52:55], v[176:191]
  s_waitcnt lgkmcnt(9)
  v_mfma_f32_32x32x16_bf16 v[192:207], v[32:35], v[56:59], v[192:207]
  v_mfma_f32_32x32x16_bf16 v[224:239], v[36:39], v[56:59], v[224:239]
  s_waitcnt lgkmcnt(8)
  v_mfma_f32_32x32x16_bf16 v[208:223], v[32:35], v[60:63], v[208:223]
  v_mfma_f32_32x32x16_bf16 v[240:255], v[36:39], v[60:63], v[240:255]
  s_waitcnt lgkmcnt(0)
  s_barrier
  v_mfma_f32_32x32x16_bf16 v[128:143], v[40:43], v[64:67], v[128:143]
  ds_read_b64_tr_b16 v[80:81], v10 offset:0
  ds_read_b64_tr_b16 v[82:83], v10 offset:1024
  ds_read_b128 v[88:91], v20 offset:0
  v_mfma_f32_32x32x16_bf16 v[160:175], v[44:47], v[64:67], v[160:175]
  ds_read_b64_tr_b16 v[84:85], v10 offset:16384
  ds_read_b64_tr_b16 v[86:87], v10 offset:17408
  v_mfma_f32_32x32x16_bf16 v[144:159], v[40:43], v[68:71], v[144:159]
  ds_read_b128 v[92:95], v20 offset:4096
  ds_read_b128 v[96:99], v20 offset:8192
  v_mfma_f32_32x32x16_bf16 v[176:191], v[44:47], v[68:71], v[176:191]
  ds_read_b128 v[100:103], v20 offset:12288
  v_mfma_f32_32x32x16_bf16 v[192:207], v[40:43], v[72:75], v[192:207]
  ds_read_b64_tr_b16 v[32:33], v10 offset:4096
  ds_read_b64_tr_b16 v[34:35], v10 offset:5120
  ds_read_b128 v[48:51], v21 offset:0
  v_mfma_f32_32x32x16_bf16 v[224:239], v[44:47], v[72:75], v[224:239]
  ds_read_b64_tr_b16 v[36:37], v10 offset:20480
  ds_read_b64_tr_b16 v[38:39], v10 offset:21504
  v_mfma_f32_32x32x16_bf16 v[208:223], v[40:43], v[76:79], v[208:223]
  ds_read_b128 v[52:55], v21 offset:4096
  ds_read_b128 v[56:59], v21 offset:8192
  v_mfma_f32_32x32x16_bf16 v[240:255], v[44:47], v[76:79], v[240:255]
  ds_read_b128 v[60:63], v21 offset:12288
  s_waitcnt lgkmcnt(13)
  v_mfma_f32_32x32x16_bf16 v[128:143], v[80:83], v[88:91], v[128:143]
  ds_read_b64_tr_b16 v[40:41], v10 offset:8192
  ds_read_b64_tr_b16 v[42:43], v10 offset:9216
  s_waitcnt lgkmcnt(13)
  v_mfma_f32_32x32x16_bf16 v[160:175], v[84:87], v[88:91], v[160:175]
  ds_read_b128 v[64:67], v22 offset:0
  s_waitcnt lgkmcnt(13)
  v_mfma_f32_32x32x16_bf16 v[144:159], v[80:83], v[92:95], v[144:159]
  ds_read_b64_tr_b16 v[44:45], v10 offset:24576
  ds_read_b64_tr_b16 v[46:47], v10 offset:25600
  v_mfma_f32_32x32x16_bf16 v[176:191], v[84:87], v[92:95], v[176:191]
  ds_read_b128 v[68:71], v22 offset:4096
  s_waitcnt lgkmcnt(15)
  v_mfma_f32_32x32x16_bf16 v[192:207], v[80:83], v[96:99], v[192:207]
  ds_read_b128 v[72:75], v22 offset:8192
  v_mfma_f32_32x32x16_bf16 v[224:239], v[84:87], v[96:99], v[224:239]
  ds_read_b128 v[76:79], v22 offset:12288
  s_waitcnt lgkmcnt(15)
  v_mfma_f32_32x32x16_bf16 v[208:223], v[80:83], v[100:103], v[208:223]
  v_mfma_f32_32x32x16_bf16 v[240:255], v[84:87], v[100:103], v[240:255]
  s_waitcnt lgkmcnt(13)
  v_mfma_f32_32x32x16_bf16 v[128:143], v[32:35], v[48:51], v[128:143]
  ds_read_b64_tr_b16 v[80:81], v10 offset:12288
  ds_read_b64_tr_b16 v[82:83], v10 offset:13312
  s_waitcnt lgkmcnt(13)
  v_mfma_f32_32x32x16_bf16 v[160:175], v[36:39], v[48:51], v[160:175]
  ds_read_b128 v[88:91], v23 offset:0
  s_waitcnt lgkmcnt(13)
  v_mfma_f32_32x32x16_bf16 v[144:159], v[32:35], v[52:55], v[144:159]
  ds_read_b64_tr_b16 v[84:85], v10 offset:28672
  ds_read_b64_tr_b16 v[86:87], v10 offset:29696
  v_mfma_f32_32x32x16_bf16 v[176:191], v[36:39], v[52:55], v[176:191]
  ds_read_b128 v[92:95], v23 offset:4096
  s_waitcnt lgkmcnt(15)
  v_mfma_f32_32x32x16_bf16 v[192:207], v[32:35], v[56:59], v[192:207]
  ds_read_b128 v[96:99], v23 offset:8192
  v_mfma_f32_32x32x16_bf16 v[224:239], v[36:39], v[56:59], v[224:239]
  ds_read_b128 v[100:103], v23 offset:12288
  s_waitcnt lgkmcnt(15)
  v_mfma_f32_32x32x16_bf16 v[208:223], v[32:35], v[60:63], v[208:223]
  v_mfma_f32_32x32x16_bf16 v[240:255], v[36:39], v[60:63], v[240:255]
  s_waitcnt lgkmcnt(13)
  v_mfma_f32_32x32x16_bf16 v[128:143], v[40:43], v[64:67], v[128:143]
  s_waitcnt lgkmcnt(11)
  v_mfma_f32_32x32x16_bf16 v[160:175], v[44:47], v[64:67], v[160:175]
  s_waitcnt lgkmcnt(10)
  v_mfma_f32_32x32x16_bf16 v[144:159], v[40:43], v[68:71], v[144:159]
  v_mfma_f32_32x32x16_bf16 v[176:191], v[44:47], v[68:71], v[176:191]
  s_waitcnt lgkmcnt(9)
  v_mfma_f32_32x32x16_bf16 v[192:207], v[40:43], v[72:75], v[192:207]
  v_mfma_f32_32x32x16_bf16 v[224:239], v[44:47], v[72:75], v[224:239]
  s_waitcnt lgkmcnt(8)
  v_mfma_f32_32x32x16_bf16 v[208:223], v[40:43], v[76:79], v[208:223]
  v_mfma_f32_32x32x16_bf16 v[240:255], v[44:47], v[76:79], v[240:255]
  s_waitcnt lgkmcnt(0)
  s_barrier
  v_mfma_f32_32x32x16_bf16 v[128:143], v[80:83], v[88:91], v[128:143]
  ds_read_b64_tr_b16 v[32:33], v8 offset:0
  ds_read_b64_tr_b16 v[34:35], v8 offset:1024
  ds_read_b128 v[48:51], v12 offset:0
  v_mfma_f32_32x32x16_bf16 v[160:175], v[84:87], v[88:91], v[160:175]
  ds_read_b64_tr_b16 v[36:37], v8 offset:16384
  ds_read_b64_tr_b16 v[38:39], v8 offset:17408
  v_mfma_f32_32x32x16_bf16 v[144:159], v[80:83], v[92:95], v[144:159]
  ds_read_b128 v[52:55], v12 offset:4096
  ds_read_b128 v[56:59], v12 offset:8192
  v_mfma_f32_32x32x16_bf16 v[176:191], v[84:87], v[92:95], v[176:191]
  ds_read_b128 v[60:63], v12 offset:12288
  v_mfma_f32_32x32x16_bf16 v[192:207], v[80:83], v[96:99], v[192:207]
  ds_read_b64_tr_b16 v[40:41], v8 offset:4096
  ds_read_b64_tr_b16 v[42:43], v8 offset:5120
  ds_read_b128 v[64:67], v13 offset:0
  v_mfma_f32_32x32x16_bf16 v[224:239], v[84:87], v[96:99], v[224:239]
  ds_read_b64_tr_b16 v[44:45], v8 offset:20480
  ds_read_b64_tr_b16 v[46:47], v8 offset:21504
  v_mfma_f32_32x32x16_bf16 v[208:223], v[80:83], v[100:103], v[208:223]
  ds_read_b128 v[68:71], v13 offset:4096
  ds_read_b128 v[72:75], v13 offset:8192
  v_mfma_f32_32x32x16_bf16 v[240:255], v[84:87], v[100:103], v[240:255]
  ds_read_b128 v[76:79], v13 offset:12288
  s_waitcnt lgkmcnt(13)
  v_mfma_f32_32x32x16_bf16 v[128:143], v[32:35], v[48:51], v[128:143]
  ds_read_b64_tr_b16 v[80:81], v8 offset:8192
  ds_read_b64_tr_b16 v[82:83], v8 offset:9216
  s_waitcnt lgkmcnt(13)
  v_mfma_f32_32x32x16_bf16 v[160:175], v[36:39], v[48:51], v[160:175]
  ds_read_b128 v[88:91], v14 offset:0
  s_waitcnt lgkmcnt(13)
  v_mfma_f32_32x32x16_bf16 v[144:159], v[32:35], v[52:55], v[144:159]
  ds_read_b64_tr_b16 v[84:85], v8 offset:24576
  ds_read_b64_tr_b16 v[86:87], v8 offset:25600
  v_mfma_f32_32x32x16_bf16 v[176:191], v[36:39], v[52:55], v[176:191]
  ds_read_b128 v[92:95], v14 offset:4096
  s_waitcnt lgkmcnt(15)
  v_mfma_f32_32x32x16_bf16 v[192:207], v[32:35], v[56:59], v[192:207]
  ds_read_b128 v[96:99], v14 offset:8192
  v_mfma_f32_32x32x16_bf16 v[224:239], v[36:39], v[56:59], v[224:239]
  ds_read_b128 v[100:103], v14 offset:12288
  s_waitcnt lgkmcnt(15)
  v_mfma_f32_32x32x16_bf16 v[208:223], v[32:35], v[60:63], v[208:223]
  s_lshl_b32 s60, s35, 7
  s_lshl_b32 s61, s37, 6
  s_add_u32 s60, s60, s61
  v_add_u32 v104, s60, v3
  v_lshlrev_b32 v105, 3, v104
  s_add_u32 s62, s4, 16875520
  s_addc_u32 s63, s5, 0
  global_load_dwordx2 v[108:109], v105, s[62:63] sc1
  global_load_dwordx2 v[110:111], v105, s[62:63] offset:256 sc1
  v_mfma_f32_32x32x16_bf16 v[240:255], v[36:39], v[60:63], v[240:255]
  s_waitcnt lgkmcnt(13)
  v_mfma_f32_32x32x16_bf16 v[128:143], v[40:43], v[64:67], v[128:143]
  ds_read_b64_tr_b16 v[32:33], v8 offset:12288
  ds_read_b64_tr_b16 v[34:35], v8 offset:13312
  s_waitcnt lgkmcnt(13)
  v_mfma_f32_32x32x16_bf16 v[160:175], v[44:47], v[64:67], v[160:175]
  ds_read_b128 v[48:51], v15 offset:0
  s_waitcnt lgkmcnt(13)
  v_mfma_f32_32x32x16_bf16 v[144:159], v[40:43], v[68:71], v[144:159]
  ds_read_b64_tr_b16 v[36:37], v8 offset:28672
  ds_read_b64_tr_b16 v[38:39], v8 offset:29696
  v_mfma_f32_32x32x16_bf16 v[176:191], v[44:47], v[68:71], v[176:191]
  ds_read_b128 v[52:55], v15 offset:4096
  s_waitcnt lgkmcnt(15)
  v_mfma_f32_32x32x16_bf16 v[192:207], v[40:43], v[72:75], v[192:207]
  ds_read_b128 v[56:59], v15 offset:8192
  v_mfma_f32_32x32x16_bf16 v[224:239], v[44:47], v[72:75], v[224:239]
  ds_read_b128 v[60:63], v15 offset:12288
  s_waitcnt lgkmcnt(15)
  v_mfma_f32_32x32x16_bf16 v[208:223], v[40:43], v[76:79], v[208:223]
  v_mfma_f32_32x32x16_bf16 v[240:255], v[44:47], v[76:79], v[240:255]
  s_waitcnt lgkmcnt(13)
  v_mfma_f32_32x32x16_bf16 v[128:143], v[80:83], v[88:91], v[128:143]
  s_waitcnt lgkmcnt(11)
  v_mfma_f32_32x32x16_bf16 v[160:175], v[84:87], v[88:91], v[160:175]
  s_waitcnt lgkmcnt(10)
  v_mfma_f32_32x32x16_bf16 v[144:159], v[80:83], v[92:95], v[144:159]
  v_mfma_f32_32x32x16_bf16 v[176:191], v[84:87], v[92:95], v[176:191]
  s_waitcnt lgkmcnt(9)
  v_mfma_f32_32x32x16_bf16 v[192:207], v[80:83], v[96:99], v[192:207]
  v_mfma_f32_32x32x16_bf16 v[224:239], v[84:87], v[96:99], v[224:239]
  s_waitcnt lgkmcnt(8)
  v_mfma_f32_32x32x16_bf16 v[208:223], v[80:83], v[100:103], v[208:223]
  v_mfma_f32_32x32x16_bf16 v[240:255], v[84:87], v[100:103], v[240:255]
  s_waitcnt lgkmcnt(0)
  s_barrier
  v_mfma_f32_32x32x16_bf16 v[128:143], v[32:35], v[48:51], v[128:143]
  ds_read_b64_tr_b16 v[40:41], v9 offset:0
  ds_read_b64_tr_b16 v[42:43], v9 offset:1024
  ds_read_b128 v[64:67], v16 offset:0
  v_mfma_f32_32x32x16_bf16 v[160:175], v[36:39], v[48:51], v[160:175]
  ds_read_b64_tr_b16 v[44:45], v9 offset:16384
  ds_read_b64_tr_b16 v[46:47], v9 offset:17408
  v_mfma_f32_32x32x16_bf16 v[144:159], v[32:35], v[52:55], v[144:159]
  ds_read_b128 v[68:71], v16 offset:4096
  ds_read_b128 v[72:75], v16 offset:8192
  v_mfma_f32_32x32x16_bf16 v[176:191], v[36:39], v[52:55], v[176:191]
  ds_read_b128 v[76:79], v16 offset:12288
  v_mfma_f32_32x32x16_bf16 v[192:207], v[32:35], v[56:59], v[192:207]
  ds_read_b64_tr_b16 v[80:81], v9 offset:4096
  ds_read_b64_tr_b16 v[82:83], v9 offset:5120
  ds_read_b128 v[88:91], v17 offset:0
  v_mfma_f32_32x32x16_bf16 v[224:239], v[36:39], v[56:59], v[224:239]
  ds_read_b64_tr_b16 v[84:85], v9 offset:20480
  ds_read_b64_tr_b16 v[86:87], v9 offset:21504
  v_mfma_f32_32x32x16_bf16 v[208:223], v[32:35], v[60:63], v[208:223]
  ds_read_b128 v[92:95], v17 offset:4096
  ds_read_b128 v[96:99], v17 offset:8192
  v_mfma_f32_32x32x16_bf16 v[240:255], v[36:39], v[60:63], v[240:255]
  ds_read_b128 v[100:103], v17 offset:12288
  s_waitcnt lgkmcnt(13)
  v_mfma_f32_32x32x16_bf16 v[128:143], v[40:43], v[64:67], v[128:143]
  ds_read_b64_tr_b16 v[32:33], v9 offset:8192
  ds_read_b64_tr_b16 v[34:35], v9 offset:9216
  s_waitcnt lgkmcnt(13)
  v_mfma_f32_32x32x16_bf16 v[160:175], v[44:47], v[64:67], v[160:175]
  ds_read_b128 v[48:51], v18 offset:0
  s_waitcnt lgkmcnt(13)
  v_mfma_f32_32x32x16_bf16 v[144:159], v[40:43], v[68:71], v[144:159]
  ds_read_b64_tr_b16 v[36:37], v9 offset:24576
  ds_read_b64_tr_b16 v[38:39], v9 offset:25600
  v_mfma_f32_32x32x16_bf16 v[176:191], v[44:47], v[68:71], v[176:191]
  ds_read_b128 v[52:55], v18 offset:4096
  s_waitcnt lgkmcnt(15)
  v_mfma_f32_32x32x16_bf16 v[192:207], v[40:43], v[72:75], v[192:207]
  ds_read_b128 v[56:59], v18 offset:8192
  v_mfma_f32_32x32x16_bf16 v[224:239], v[44:47], v[72:75], v[224:239]
  ds_read_b128 v[60:63], v18 offset:12288
  s_waitcnt lgkmcnt(15)
  v_mfma_f32_32x32x16_bf16 v[208:223], v[40:43], v[76:79], v[208:223]
  v_mfma_f32_32x32x16_bf16 v[240:255], v[44:47], v[76:79], v[240:255]
  s_waitcnt lgkmcnt(13)
  v_mfma_f32_32x32x16_bf16 v[128:143], v[80:83], v[88:91], v[128:143]
  ds_read_b64_tr_b16 v[40:41], v9 offset:12288
  ds_read_b64_tr_b16 v[42:43], v9 offset:13312
  s_waitcnt lgkmcnt(13)
  v_mfma_f32_32x32x16_bf16 v[160:175], v[84:87], v[88:91], v[160:175]
  ds_read_b128 v[64:67], v19 offset:0
  s_waitcnt lgkmcnt(13)
  v_mfma_f32_32x32x16_bf16 v[144:159], v[80:83], v[92:95], v[144:159]
  ds_read_b64_tr_b16 v[44:45], v9 offset:28672
  ds_read_b64_tr_b16 v[46:47], v9 offset:29696
  v_mfma_f32_32x32x16_bf16 v[176:191], v[84:87], v[92:95], v[176:191]
  ds_read_b128 v[68:71], v19 offset:4096
  s_waitcnt lgkmcnt(15)
  v_mfma_f32_32x32x16_bf16 v[192:207], v[80:83], v[96:99], v[192:207]
  ds_read_b128 v[72:75], v19 offset:8192
  v_mfma_f32_32x32x16_bf16 v[224:239], v[84:87], v[96:99], v[224:239]
  ds_read_b128 v[76:79], v19 offset:12288
  s_waitcnt lgkmcnt(15)
  v_mfma_f32_32x32x16_bf16 v[208:223], v[80:83], v[100:103], v[208:223]
  v_mfma_f32_32x32x16_bf16 v[240:255], v[84:87], v[100:103], v[240:255]
  s_waitcnt lgkmcnt(13)
  v_mfma_f32_32x32x16_bf16 v[128:143], v[32:35], v[48:51], v[128:143]
  s_waitcnt lgkmcnt(11)
  v_mfma_f32_32x32x16_bf16 v[160:175], v[36:39], v[48:51], v[160:175]
  s_waitcnt lgkmcnt(10)
  v_mfma_f32_32x32x16_bf16 v[144:159], v[32:35], v[52:55], v[144:159]
  v_mfma_f32_32x32x16_bf16 v[176:191], v[36:39], v[52:55], v[176:191]
  s_waitcnt lgkmcnt(9)
  v_mfma_f32_32x32x16_bf16 v[192:207], v[32:35], v[56:59], v[192:207]
  v_mfma_f32_32x32x16_bf16 v[224:239], v[36:39], v[56:59], v[224:239]
  s_waitcnt lgkmcnt(8)
  v_mfma_f32_32x32x16_bf16 v[208:223], v[32:35], v[60:63], v[208:223]
  v_mfma_f32_32x32x16_bf16 v[240:255], v[36:39], v[60:63], v[240:255]
  s_lshl_b32 s60, s36, 14
  s_cmp_eq_u32 s36, 3
  s_cselect_b32 s60, 98304, s60
  v_lshlrev_b32 v104, 4, v1
  v_add_u32 v104, s60, v104
  s_waitcnt lgkmcnt(0)
  v_mfma_f32_32x32x16_bf16 v[128:143], v[40:43], v[64:67], v[128:143]
  v_mfma_f32_32x32x16_bf16 v[160:175], v[44:47], v[64:67], v[160:175]
  v_mfma_f32_32x32x16_bf16 v[144:159], v[40:43], v[68:71], v[144:159]
  v_mfma_f32_32x32x16_bf16 v[176:191], v[44:47], v[68:71], v[176:191]
  v_mfma_f32_32x32x16_bf16 v[192:207], v[40:43], v[72:75], v[192:207]
  v_mfma_f32_32x32x16_bf16 v[224:239], v[44:47], v[72:75], v[224:239]
  v_mfma_f32_32x32x16_bf16 v[208:223], v[40:43], v[76:79], v[208:223]
  v_mfma_f32_32x32x16_bf16 v[240:255], v[44:47], v[76:79], v[240:255]
  s_nop 8
  ds_write_b128 v104, v[192:195] offset:0
  ds_write_b128 v104, v[196:199] offset:1024
  ds_write_b128 v104, v[200:203] offset:2048
  ds_write_b128 v104, v[204:207] offset:3072
  ds_write_b128 v104, v[208:211] offset:4096
  ds_write_b128 v104, v[212:215] offset:5120
  ds_write_b128 v104, v[216:219] offset:6144
  ds_write_b128 v104, v[220:223] offset:7168
  ds_write_b128 v104, v[224:227] offset:8192
  ds_write_b128 v104, v[228:231] offset:9216
  ds_write_b128 v104, v[232:235] offset:10240
  ds_write_b128 v104, v[236:239] offset:11264
  ds_write_b128 v104, v[240:243] offset:12288
  ds_write_b128 v104, v[244:247] offset:13312
  ds_write_b128 v104, v[248:251] offset:14336
  ds_write_b128 v104, v[252:255] offset:15360
  s_waitcnt vmcnt(0) lgkmcnt(0)
  s_barrier
p1_join:
  s_lshl_b32 s39, s36, 7
  v_lshlrev_b32 v82, 2, v3
  v_add_u32 v82, s39, v82
  v_add_u32 v82, 162560, v82
  ds_read_b32 v90, v82
  ds_read_b32 v91, v82 offset:512
  v_mov_b32 v32, 0
  v_mov_b32 v33, 0
  v_mov_b32 v34, 0
  v_mov_b32 v35, 0
  v_mov_b32 v36, 0
  v_mov_b32 v37, 0
  v_mov_b32 v38, 0
  v_mov_b32 v39, 0
  v_mov_b32 v40, 0
  v_mov_b32 v41, 0
  v_mov_b32 v42, 0
  v_mov_b32 v43, 0
  v_mov_b32 v44, 0
  v_mov_b32 v45, 0
  v_mov_b32 v46, 0
  v_mov_b32 v47, 0
  v_rcp_f32 v98, v109
  v_mul_f32 v96, v109, v109
  v_mul_f32 v86, 0xc0135761, v98
  v_mul_f32 v89, v98, v98
  v_mul_f32 v89, v89, v98
  v_mul_f32 v94, 0xbdd2d3e8, v89
  v_rcp_f32 v99, v111
  v_mul_f32 v97, v111, v111
  v_mul_f32 v87, 0xc0135761, v99
  v_mul_f32 v89, v99, v99
  v_mul_f32 v89, v89, v99
  v_mul_f32 v95, 0xbdd2d3e8, v89
  s_mov_b32 s20, s4
  s_mov_b32 s21, s5
  s_mov_b32 s22, 0x700000
  s_mov_b32 s23, 0x20000
  s_add_u32 s24, s4, 0x940000
  s_addc_u32 s25, s5, 0
  s_mov_b32 s26, 0x200000
  s_mov_b32 s27, 0x20000
  v_cvt_pk_bf16_f32 v92, v108, v108
  v_cvt_pk_bf16_f32 v93, v110, v110
  v_cmp_gt_u32 vcc, 32, v1
  s_nop 1
  v_cndmask_b32 v40, 0, v92, vcc
  v_cndmask_b32 v44, 0, v93, vcc
  s_lshl_b32 s33, s35, 7
  s_lshl_b32 s39, s37, 6
  s_add_u32 s33, s33, s39
  v_add_u32 v84, s33, v3
  v_lshlrev_b32 v112, 4, v84
  v_lshl_add_u32 v112, v2, 15, v112
  v_add_u32 v113, 512, v112
  s_waitcnt lgkmcnt(0)
  v_cndmask_b32 v32, 0, v90, vcc
  v_cndmask_b32 v36, 0, v91, vcc
  s_nop 0
  v_mfma_f32_32x32x16_bf16 v[128:143], v[32:35], v[40:43], v[128:143]
  v_mfma_f32_32x32x16_bf16 v[144:159], v[32:35], v[44:47], v[144:159]
  v_mfma_f32_32x32x16_bf16 v[160:175], v[36:39], v[40:43], v[160:175]
  v_mfma_f32_32x32x16_bf16 v[176:191], v[36:39], v[44:47], v[176:191]
  s_cmp_eq_u32 s37, 0
  s_cbranch_scc1 p1_pfC
  s_lshl_b32 s39, s36, 2
  v_mov_b32 v114, 163584
  v_add_u32 v114, s39, v114
  v_mov_b32 v115, 1
  ds_write_b32 v114, v115 offset:64
  s_branch p1_pfE
p1_pfC:
  s_mov_b32 s8, s56
  s_mov_b32 s9, s57
  s_mov_b32 s10, 0x1c0000
  s_mov_b32 s11, 0x20000
  s_and_b32 s13, s2, 7
  s_lshr_b32 s14, s2, 3
  s_lshr_b32 s13, s13, 2
  s_lshl_b32 s13, s13, 2
  s_lshr_b32 s14, s14, 3
  s_add_u32 s13, s13, s14
  v_lshrrev_b32 v115, 3, v1
  v_bfe_u32 v116, v1, 4, 1
  v_lshlrev_b32 v116, 2, v116
  v_and_b32 v114, 7, v1
  v_xor_b32 v114, v114, v116
  v_lshlrev_b32 v114, 4, v114
  v_lshl_add_u32 v114, v115, 10, v114
  s_lshl_b32 s39, s13, 7
  v_add_u32 v114, s39, v114
  s_mul_i32 s44, s32, 458752
  s_mul_i32 s45, s32, 34816
  v_mov_b32 v115, 163584
p1_pfE:
  s_nop 7
  s_nop 4
  s_mul_i32 s61, s34, 14
  s_lshl_b32 s39, s36, 2
  s_add_u32 s61, s61, s39
  s_lshl_b32 s61, s61, 15
  s_cmp_lg_u32 s36, 3
  s_cbranch_scc1 p1_noy
  s_lshl_b32 s39, s37, 12
  s_add_u32 s39, s39, 147456
  v_lshlrev_b32 v208, 10, v2
  v_lshl_add_u32 v208, v3, 2, v208
  v_add_u32 v208, s39, v208
  v_lshlrev_b32 v209, 4, v1
  v_add_u32 v209, s39, v209
  v_lshrrev_b32 v210, 4, v1
  v_lshlrev_b32 v210, 13, v210
  v_and_b32 v211, 15, v1
  v_lshl_add_u32 v210, v211, 4, v210
  s_lshl_b32 s39, s33, 2
  v_add_u32 v210, s39, v210
  v_mul_f32 v136, v136, v98
  v_mul_f32 v168, v168, v98
  v_cvt_pk_bf16_f32 v136, v136, v168
  ds_write_b32 v208, v136 offset:0
  v_mul_f32 v137, v137, v98
  v_mul_f32 v169, v169, v98
  v_cvt_pk_bf16_f32 v137, v137, v169
  ds_write_b32 v208, v137 offset:256
  v_mul_f32 v138, v138, v98
  v_mul_f32 v170, v170, v98
  v_cvt_pk_bf16_f32 v138, v138, v170
  ds_write_b32 v208, v138 offset:512
  v_mul_f32 v139, v139, v98
  v_mul_f32 v171, v171, v98
  v_cvt_pk_bf16_f32 v139, v139, v171
  ds_write_b32 v208, v139 offset:768
  v_mul_f32 v152, v152, v99
  v_mul_f32 v184, v184, v99
  v_cvt_pk_bf16_f32 v152, v152, v184
  ds_write_b32 v208, v152 offset:128
  v_mul_f32 v153, v153, v99
  v_mul_f32 v185, v185, v99
  v_cvt_pk_bf16_f32 v153, v153, v185
  ds_write_b32 v208, v153 offset:384
  v_mul_f32 v154, v154, v99
  v_mul_f32 v186, v186, v99
  v_cvt_pk_bf16_f32 v154, v154, v186
  ds_write_b32 v208, v154 offset:640
  v_mul_f32 v155, v155, v99
  v_mul_f32 v187, v187, v99
  v_cvt_pk_bf16_f32 v155, v155, v187
  ds_write_b32 v208, v155 offset:896
  v_mul_f32 v140, v140, v98
  v_mul_f32 v172, v172, v98
  v_cvt_pk_bf16_f32 v140, v140, v172
  ds_write_b32 v208, v140 offset:2048
  v_mul_f32 v141, v141, v98
  v_mul_f32 v173, v173, v98
  v_cvt_pk_bf16_f32 v141, v141, v173
  ds_write_b32 v208, v141 offset:2304
  v_mul_f32 v142, v142, v98
  v_mul_f32 v174, v174, v98
  v_cvt_pk_bf16_f32 v142, v142, v174
  ds_write_b32 v208, v142 offset:2560
  v_mul_f32 v143, v143, v98
  v_mul_f32 v175, v175, v98
  v_cvt_pk_bf16_f32 v143, v143, v175
  ds_write_b32 v208, v143 offset:2816
  v_mul_f32 v156, v156, v99
  v_mul_f32 v188, v188, v99
  v_cvt_pk_bf16_f32 v156, v156, v188
  ds_write_b32 v208, v156 offset:2176
  v_mul_f32 v157, v157, v99
  v_mul_f32 v189, v189, v99
  v_cvt_pk_bf16_f32 v157, v157, v189
  ds_write_b32 v208, v157 offset:2432
  v_mul_f32 v158, v158, v99
  v_mul_f32 v190, v190, v99
  v_cvt_pk_bf16_f32 v158, v158, v190
  ds_write_b32 v208, v158 offset:2688
  v_mul_f32 v159, v159, v99
  v_mul_f32 v191, v191, v99
  v_cvt_pk_bf16_f32 v159, v159, v191
  ds_write_b32 v208, v159 offset:2944
  s_waitcnt lgkmcnt(0)
  ds_read_b128 v[212:215], v209 offset:0
  ds_read_b128 v[216:219], v209 offset:1024
  ds_read_b128 v[220:223], v209 offset:2048
  ds_read_b128 v[224:227], v209 offset:3072
  s_waitcnt lgkmcnt(0)
  s_lshl_b32 s60, s34, 4
  s_add_u32 s60, s60, 0
  s_lshl_b32 s60, s60, 13
  buffer_store_dwordx4 v[212:215], v210, s[24:27], s60 offen sc1
  s_lshl_b32 s60, s34, 4
  s_add_u32 s60, s60, 4
  s_lshl_b32 s60, s60, 13
  buffer_store_dwordx4 v[216:219], v210, s[24:27], s60 offen sc1
  s_lshl_b32 s60, s34, 4
  s_add_u32 s60, s60, 8
  s_lshl_b32 s60, s60, 13
  buffer_store_dwordx4 v[220:223], v210, s[24:27], s60 offen sc1
  s_lshl_b32 s60, s34, 4
  s_add_u32 s60, s60, 12
  s_lshl_b32 s60, s60, 13
  buffer_store_dwordx4 v[224:227], v210, s[24:27], s60 offen sc1
  s_mov_b32 s60, s61
  s_cmp_lg_u32 s37, 0
  s_cbranch_scc1 p1_y7
  v_mul_f32 v100, v128, v128
  v_fma_f32 v100, v100, v94, v86
  v_mul_f32 v100, v100, v128
  v_mul_f32 v101, v129, v129
  v_fma_f32 v101, v101, v94, v86
  v_mul_f32 v101, v101, v129
  v_mul_f32 v102, v130, v130
  v_fma_f32 v102, v102, v94, v86
  v_mul_f32 v102, v102, v130
  v_mul_f32 v103, v131, v131
  v_fma_f32 v103, v103, v94, v86
  v_mul_f32 v103, v103, v131
  v_exp_f32 v100, v100
  v_exp_f32 v101, v101
  v_exp_f32 v102, v102
  v_exp_f32 v103, v103
  v_mul_f32 v128, v128, v160
  v_fma_f32 v100, v100, v96, v96
  v_mul_f32 v129, v129, v161
  v_fma_f32 v101, v101, v96, v96
  v_mul_f32 v130, v130, v162
  v_fma_f32 v102, v102, v96, v96
  v_mul_f32 v131, v131, v163
  v_fma_f32 v103, v103, v96, v96
  v_rcp_f32 v100, v100
  v_rcp_f32 v101, v101
  v_rcp_f32 v102, v102
  v_rcp_f32 v103, v103
  v_mul_f32 v128, v128, v100
  v_mul_f32 v129, v129, v101
  v_mul_f32 v130, v130, v102
  v_mul_f32 v131, v131, v103
  v_cvt_pk_bf16_f32 v192, v128, v129
  v_cvt_pk_bf16_f32 v193, v130, v131
  v_mul_f32 v100, v132, v132
  v_fma_f32 v100, v100, v94, v86
  v_mul_f32 v100, v100, v132
  v_mul_f32 v101, v133, v133
  v_fma_f32 v101, v101, v94, v86
  v_mul_f32 v101, v101, v133
  v_mul_f32 v102, v134, v134
  v_fma_f32 v102, v102, v94, v86
  v_mul_f32 v102, v102, v134
  v_mul_f32 v103, v135, v135
  v_fma_f32 v103, v103, v94, v86
  v_mul_f32 v103, v103, v135
  v_exp_f32 v100, v100
  v_exp_f32 v101, v101
  v_exp_f32 v102, v102
  v_exp_f32 v103, v103
  v_mul_f32 v132, v132, v164
  v_fma_f32 v100, v100, v96, v96
  v_mul_f32 v133, v133, v165
  v_fma_f32 v101, v101, v96, v96
  v_mul_f32 v134, v134, v166
  v_fma_f32 v102, v102, v96, v96
  v_mul_f32 v135, v135, v167
  v_fma_f32 v103, v103, v96, v96
  v_rcp_f32 v100, v100
  v_rcp_f32 v101, v101
  v_rcp_f32 v102, v102
  v_rcp_f32 v103, v103
  v_mul_f32 v132, v132, v100
  v_mul_f32 v133, v133, v101
  v_mul_f32 v134, v134, v102
  v_mul_f32 v135, v135, v103
  v_cvt_pk_bf16_f32 v194, v132, v133
  v_cvt_pk_bf16_f32 v195, v134, v135
  s_nop 0
  v_permlane32_swap_b32 v192, v194
  v_permlane32_swap_b32 v193, v195
  buffer_store_dwordx4 v[192:195], v112, s[20:23], s60 offen sc1
  v_mul_f32 v100, v144, v144
  v_fma_f32 v100, v100, v95, v87
  v_mul_f32 v100, v100, v144
  v_mul_f32 v101, v145, v145
  v_fma_f32 v101, v101, v95, v87
  v_mul_f32 v101, v101, v145
  v_mul_f32 v102, v146, v146
  v_fma_f32 v102, v102, v95, v87
  v_mul_f32 v102, v102, v146
  v_mul_f32 v103, v147, v147
  v_fma_f32 v103, v103, v95, v87
  v_mul_f32 v103, v103, v147
  v_exp_f32 v100, v100
  v_exp_f32 v101, v101
  v_exp_f32 v102, v102
  v_exp_f32 v103, v103
  v_mul_f32 v144, v144, v176
  v_fma_f32 v100, v100, v97, v97
  v_mul_f32 v145, v145, v177
  v_fma_f32 v101, v101, v97, v97
  v_mul_f32 v146, v146, v178
  v_fma_f32 v102, v102, v97, v97
  v_mul_f32 v147, v147, v179
  v_fma_f32 v103, v103, v97, v97
  v_rcp_f32 v100, v100
  v_rcp_f32 v101, v101
  v_rcp_f32 v102, v102
  v_rcp_f32 v103, v103
  v_mul_f32 v144, v144, v100
  v_mul_f32 v145, v145, v101
  v_mul_f32 v146, v146, v102
  v_mul_f32 v147, v147, v103
  v_cvt_pk_bf16_f32 v196, v144, v145
  v_cvt_pk_bf16_f32 v197, v146, v147
  v_mul_f32 v100, v148, v148
  v_fma_f32 v100, v100, v95, v87
  v_mul_f32 v100, v100, v148
  v_mul_f32 v101, v149, v149
  v_fma_f32 v101, v101, v95, v87
  v_mul_f32 v101, v101, v149
  v_mul_f32 v102, v150, v150
  v_fma_f32 v102, v102, v95, v87
  v_mul_f32 v102, v102, v150
  v_mul_f32 v103, v151, v151
  v_fma_f32 v103, v103, v95, v87
  v_mul_f32 v103, v103, v151
  v_exp_f32 v100, v100
  v_exp_f32 v101, v101
  v_exp_f32 v102, v102
  v_exp_f32 v103, v103
  v_mul_f32 v148, v148, v180
  v_fma_f32 v100, v100, v97, v97
  v_mul_f32 v149, v149, v181
  v_fma_f32 v101, v101, v97, v97
  v_mul_f32 v150, v150, v182
  v_fma_f32 v102, v102, v97, v97
  v_mul_f32 v151, v151, v183
  v_fma_f32 v103, v103, v97, v97
  v_rcp_f32 v100, v100
  v_rcp_f32 v101, v101
  v_rcp_f32 v102, v102
  v_rcp_f32 v103, v103
  v_mul_f32 v148, v148, v100
  v_mul_f32 v149, v149, v101
  v_mul_f32 v150, v150, v102
  v_mul_f32 v151, v151, v103
  v_cvt_pk_bf16_f32 v198, v148, v149
  v_cvt_pk_bf16_f32 v199, v150, v151
  s_nop 0
  v_permlane32_swap_b32 v196, v198
  v_permlane32_swap_b32 v197, v199
  buffer_store_dwordx4 v[196:199], v113, s[20:23], s60 offen sc1
  s_waitcnt vmcnt(2)
  v_mov_b32 v208, 163584
  v_mov_b32 v209, 1
  ds_write_b32 v208, v209 offset:80
  s_branch p1_end
p1_y7:
  v_mul_f32 v100, v128, v128
  v_fma_f32 v100, v100, v94, v86
  v_mul_f32 v100, v100, v128
  v_mul_f32 v101, v129, v129
  v_fma_f32 v101, v101, v94, v86
  v_mul_f32 v101, v101, v129
  v_mul_f32 v102, v130, v130
  v_fma_f32 v102, v102, v94, v86
  v_mul_f32 v102, v102, v130
  v_mul_f32 v103, v131, v131
  v_fma_f32 v103, v103, v94, v86
  v_mul_f32 v103, v103, v131
  v_exp_f32 v100, v100
  v_exp_f32 v101, v101
  v_exp_f32 v102, v102
  v_exp_f32 v103, v103
  v_mul_f32 v128, v128, v160
  v_fma_f32 v100, v100, v96, v96
  v_mul_f32 v129, v129, v161
  v_fma_f32 v101, v101, v96, v96
  v_mul_f32 v130, v130, v162
  v_fma_f32 v102, v102, v96, v96
  v_mul_f32 v131, v131, v163
  v_fma_f32 v103, v103, v96, v96
  v_rcp_f32 v100, v100
  v_rcp_f32 v101, v101
  v_rcp_f32 v102, v102
  v_rcp_f32 v103, v103
  v_mul_f32 v128, v128, v100
  v_mul_f32 v129, v129, v101
  v_mul_f32 v130, v130, v102
  v_mul_f32 v131, v131, v103
  v_cvt_pk_bf16_f32 v192, v128, v129
  v_cvt_pk_bf16_f32 v193, v130, v131
  v_mul_f32 v100, v132, v132
  v_fma_f32 v100, v100, v94, v86
  v_mul_f32 v100, v100, v132
  v_mul_f32 v101, v133, v133
  v_fma_f32 v101, v101, v94, v86
  v_mul_f32 v101, v101, v133
  v_mul_f32 v102, v134, v134
  v_fma_f32 v102, v102, v94, v86
  v_mul_f32 v102, v102, v134
  v_mul_f32 v103, v135, v135
  v_fma_f32 v103, v103, v94, v86
  v_mul_f32 v103, v103, v135
  v_exp_f32 v100, v100
  v_exp_f32 v101, v101
  v_exp_f32 v102, v102
  v_exp_f32 v103, v103
  v_mul_f32 v132, v132, v164
  v_fma_f32 v100, v100, v96, v96
  v_mul_f32 v133, v133, v165
  v_fma_f32 v101, v101, v96, v96
  v_mul_f32 v134, v134, v166
  v_fma_f32 v102, v102, v96, v96
  v_mul_f32 v135, v135, v167
  v_fma_f32 v103, v103, v96, v96
  v_rcp_f32 v100, v100
  v_rcp_f32 v101, v101
  v_rcp_f32 v102, v102
  v_rcp_f32 v103, v103
  v_mul_f32 v132, v132, v100
  v_mul_f32 v133, v133, v101
  v_mul_f32 v134, v134, v102
  v_mul_f32 v135, v135, v103
  v_cvt_pk_bf16_f32 v194, v132, v133
  v_cvt_pk_bf16_f32 v195, v134, v135
  s_nop 0
  v_permlane32_swap_b32 v192, v194
  v_permlane32_swap_b32 v193, v195
  buffer_store_dwordx4 v[192:195], v112, s[20:23], s60 offen sc1
  v_mul_f32 v100, v144, v144
  v_fma_f32 v100, v100, v95, v87
  v_mul_f32 v100, v100, v144
  v_mul_f32 v101, v145, v145
  v_fma_f32 v101, v101, v95, v87
  v_mul_f32 v101, v101, v145
  v_mul_f32 v102, v146, v146
  v_fma_f32 v102, v102, v95, v87
  v_mul_f32 v102, v102, v146
  v_mul_f32 v103, v147, v147
  v_fma_f32 v103, v103, v95, v87
  v_mul_f32 v103, v103, v147
  v_exp_f32 v100, v100
  v_exp_f32 v101, v101
  v_exp_f32 v102, v102
  v_exp_f32 v103, v103
  v_mul_f32 v144, v144, v176
  v_fma_f32 v100, v100, v97, v97
  v_mul_f32 v145, v145, v177
  v_fma_f32 v101, v101, v97, v97
  v_mul_f32 v146, v146, v178
  v_fma_f32 v102, v102, v97, v97
  v_mul_f32 v147, v147, v179
  v_fma_f32 v103, v103, v97, v97
  v_rcp_f32 v100, v100
  v_rcp_f32 v101, v101
  v_rcp_f32 v102, v102
  v_rcp_f32 v103, v103
  v_mul_f32 v144, v144, v100
  v_mul_f32 v145, v145, v101
  v_mul_f32 v146, v146, v102
  v_mul_f32 v147, v147, v103
  v_cvt_pk_bf16_f32 v196, v144, v145
  v_cvt_pk_bf16_f32 v197, v146, v147
  v_mul_f32 v100, v148, v148
  v_fma_f32 v100, v100, v95, v87
  v_mul_f32 v100, v100, v148
  v_mul_f32 v101, v149, v149
  v_fma_f32 v101, v101, v95, v87
  v_mul_f32 v101, v101, v149
  v_mul_f32 v102, v150, v150
  v_fma_f32 v102, v102, v95, v87
  v_mul_f32 v102, v102, v150
  v_mul_f32 v103, v151, v151
  v_fma_f32 v103, v103, v95, v87
  v_mul_f32 v103, v103, v151
  v_exp_f32 v100, v100
  v_exp_f32 v101, v101
  v_exp_f32 v102, v102
  v_exp_f32 v103, v103
  v_mul_f32 v148, v148, v180
  v_fma_f32 v100, v100, v97, v97
  v_mul_f32 v149, v149, v181
  v_fma_f32 v101, v101, v97, v97
  v_mul_f32 v150, v150, v182
  v_fma_f32 v102, v102, v97, v97
  v_mul_f32 v151, v151, v183
  v_fma_f32 v103, v103, v97, v97
  v_rcp_f32 v100, v100
  v_rcp_f32 v101, v101
  v_rcp_f32 v102, v102
  v_rcp_f32 v103, v103
  v_mul_f32 v148, v148, v100
  v_mul_f32 v149, v149, v101
  v_mul_f32 v150, v150, v102
  v_mul_f32 v151, v151, v103
  v_cvt_pk_bf16_f32 v198, v148, v149
  v_cvt_pk_bf16_f32 v199, v150, v151
  s_nop 0
  v_permlane32_swap_b32 v196, v198
  v_permlane32_swap_b32 v197, v199
  buffer_store_dwordx4 v[196:199], v113, s[20:23], s60 offen sc1
  s_waitcnt vmcnt(2)
  v_mov_b32 v208, 163584
  s_mov_b32 s58, 0
lw_6:
  ds_read_b128 v[212:215], v208 offset:80
  s_waitcnt lgkmcnt(0)
  v_min_u32 v212, v212, v213
  v_min_u32 v214, v214, v215
  v_min_u32 v212, v212, v214
  s_nop 0
  v_readfirstlane_b32 s59, v212
  s_nop 2
  s_cmp_ge_u32 s59, 1
  s_cbranch_scc1 ld_7
  s_add_u32 s58, s58, 1
  s_cmp_lt_u32 s58, 131072
  s_cbranch_scc1 lw_6
ld_7:
  s_add_u32 s61, s34, 48
  s_add_u32 s62, s4, 0x1000000
  s_addc_u32 s63, s5, 0
  s_lshl_b32 s59, s61, 7
  v_mov_b32 v210, s59
  v_mov_b32 v211, 1
  s_mov_b64 exec, 1
  global_atomic_add v210, v211, s[62:63] sc1
  s_mov_b64 exec, -1
  s_branch p1_end
p1_noy:
  s_add_u32 s60, s61, 0
  v_mul_f32 v100, v128, v128
  v_fma_f32 v100, v100, v94, v86
  v_mul_f32 v100, v100, v128
  v_mul_f32 v101, v129, v129
  v_fma_f32 v101, v101, v94, v86
  v_mul_f32 v101, v101, v129
  v_mul_f32 v102, v130, v130
  v_fma_f32 v102, v102, v94, v86
  v_mul_f32 v102, v102, v130
  v_mul_f32 v103, v131, v131
  v_fma_f32 v103, v103, v94, v86
  v_mul_f32 v103, v103, v131
  v_exp_f32 v100, v100
  v_exp_f32 v101, v101
  v_exp_f32 v102, v102
  v_exp_f32 v103, v103
  v_mul_f32 v128, v128, v160
  v_fma_f32 v100, v100, v96, v96
  v_mul_f32 v129, v129, v161
  v_fma_f32 v101, v101, v96, v96
  v_mul_f32 v130, v130, v162
  v_fma_f32 v102, v102, v96, v96
  v_mul_f32 v131, v131, v163
  v_fma_f32 v103, v103, v96, v96
  v_rcp_f32 v100, v100
  v_rcp_f32 v101, v101
  v_rcp_f32 v102, v102
  v_rcp_f32 v103, v103
  v_mul_f32 v128, v128, v100
  v_mul_f32 v129, v129, v101
  v_mul_f32 v130, v130, v102
  v_mul_f32 v131, v131, v103
  v_cvt_pk_bf16_f32 v192, v128, v129
  v_cvt_pk_bf16_f32 v193, v130, v131
  v_mul_f32 v100, v132, v132
  v_fma_f32 v100, v100, v94, v86
  v_mul_f32 v100, v100, v132
  v_mul_f32 v101, v133, v133
  v_fma_f32 v101, v101, v94, v86
  v_mul_f32 v101, v101, v133
  v_mul_f32 v102, v134, v134
  v_fma_f32 v102, v102, v94, v86
  v_mul_f32 v102, v102, v134
  v_mul_f32 v103, v135, v135
  v_fma_f32 v103, v103, v94, v86
  v_mul_f32 v103, v103, v135
  v_exp_f32 v100, v100
  v_exp_f32 v101, v101
  v_exp_f32 v102, v102
  v_exp_f32 v103, v103
  v_mul_f32 v132, v132, v164
  v_fma_f32 v100, v100, v96, v96
  v_mul_f32 v133, v133, v165
  v_fma_f32 v101, v101, v96, v96
  v_mul_f32 v134, v134, v166
  v_fma_f32 v102, v102, v96, v96
  v_mul_f32 v135, v135, v167
  v_fma_f32 v103, v103, v96, v96
  v_rcp_f32 v100, v100
  v_rcp_f32 v101, v101
  v_rcp_f32 v102, v102
  v_rcp_f32 v103, v103
  v_mul_f32 v132, v132, v100
  v_mul_f32 v133, v133, v101
  v_mul_f32 v134, v134, v102
  v_mul_f32 v135, v135, v103
  v_cvt_pk_bf16_f32 v194, v132, v133
  v_cvt_pk_bf16_f32 v195, v134, v135
  s_nop 0
  v_permlane32_swap_b32 v192, v194
  v_permlane32_swap_b32 v193, v195
  buffer_store_dwordx4 v[192:195], v112, s[20:23], s60 offen sc1
  v_mul_f32 v100, v144, v144
  v_fma_f32 v100, v100, v95, v87
  v_mul_f32 v100, v100, v144
  v_mul_f32 v101, v145, v145
  v_fma_f32 v101, v101, v95, v87
  v_mul_f32 v101, v101, v145
  v_mul_f32 v102, v146, v146
  v_fma_f32 v102, v102, v95, v87
  v_mul_f32 v102, v102, v146
  v_mul_f32 v103, v147, v147
  v_fma_f32 v103, v103, v95, v87
  v_mul_f32 v103, v103, v147
  v_exp_f32 v100, v100
  v_exp_f32 v101, v101
  v_exp_f32 v102, v102
  v_exp_f32 v103, v103
  v_mul_f32 v144, v144, v176
  v_fma_f32 v100, v100, v97, v97
  v_mul_f32 v145, v145, v177
  v_fma_f32 v101, v101, v97, v97
  v_mul_f32 v146, v146, v178
  v_fma_f32 v102, v102, v97, v97
  v_mul_f32 v147, v147, v179
  v_fma_f32 v103, v103, v97, v97
  v_rcp_f32 v100, v100
  v_rcp_f32 v101, v101
  v_rcp_f32 v102, v102
  v_rcp_f32 v103, v103
  v_mul_f32 v144, v144, v100
  v_mul_f32 v145, v145, v101
  v_mul_f32 v146, v146, v102
  v_mul_f32 v147, v147, v103
  v_cvt_pk_bf16_f32 v196, v144, v145
  v_cvt_pk_bf16_f32 v197, v146, v147
  v_mul_f32 v100, v148, v148
  v_fma_f32 v100, v100, v95, v87
  v_mul_f32 v100, v100, v148
  v_mul_f32 v101, v149, v149
  v_fma_f32 v101, v101, v95, v87
  v_mul_f32 v101, v101, v149
  v_mul_f32 v102, v150, v150
  v_fma_f32 v102, v102, v95, v87
  v_mul_f32 v102, v102, v150
  v_mul_f32 v103, v151, v151
  v_fma_f32 v103, v103, v95, v87
  v_mul_f32 v103, v103, v151
  v_exp_f32 v100, v100
  v_exp_f32 v101, v101
  v_exp_f32 v102, v102
  v_exp_f32 v103, v103
  v_mul_f32 v148, v148, v180
  v_fma_f32 v100, v100, v97, v97
  v_mul_f32 v149, v149, v181
  v_fma_f32 v101, v101, v97, v97
  v_mul_f32 v150, v150, v182
  v_fma_f32 v102, v102, v97, v97
  v_mul_f32 v151, v151, v183
  v_fma_f32 v103, v103, v97, v97
  v_rcp_f32 v100, v100
  v_rcp_f32 v101, v101
  v_rcp_f32 v102, v102
  v_rcp_f32 v103, v103
  v_mul_f32 v148, v148, v100
  v_mul_f32 v149, v149, v101
  v_mul_f32 v150, v150, v102
  v_mul_f32 v151, v151, v103
  v_cvt_pk_bf16_f32 v198, v148, v149
  v_cvt_pk_bf16_f32 v199, v150, v151
  s_nop 0
  v_permlane32_swap_b32 v196, v198
  v_permlane32_swap_b32 v197, v199
  buffer_store_dwordx4 v[196:199], v113, s[20:23], s60 offen sc1
  s_cmp_eq_u32 s37, 0
  s_cbranch_scc1 p1_wf
  s_waitcnt vmcnt(2)
  s_lshl_b32 s39, s36, 2
  v_mov_b32 v208, 163584
  v_add_u32 v208, s39, v208
  v_mov_b32 v209, 1
  ds_write_b32 v208, v209 offset:84
p1_wf:
  s_add_u32 s60, s61, 65536
  v_mul_f32 v100, v136, v136
  v_fma_f32 v100, v100, v94, v86
  v_mul_f32 v100, v100, v136
  v_mul_f32 v101, v137, v137
  v_fma_f32 v101, v101, v94, v86
  v_mul_f32 v101, v101, v137
  v_mul_f32 v102, v138, v138
  v_fma_f32 v102, v102, v94, v86
  v_mul_f32 v102, v102, v138
  v_mul_f32 v103, v139, v139
  v_fma_f32 v103, v103, v94, v86
  v_mul_f32 v103, v103, v139
  v_exp_f32 v100, v100
  v_exp_f32 v101, v101
  v_exp_f32 v102, v102
  v_exp_f32 v103, v103
  v_mul_f32 v136, v136, v168
  v_fma_f32 v100, v100, v96, v96
  v_mul_f32 v137, v137, v169
  v_fma_f32 v101, v101, v96, v96
  v_mul_f32 v138, v138, v170
  v_fma_f32 v102, v102, v96, v96
  v_mul_f32 v139, v139, v171
  v_fma_f32 v103, v103, v96, v96
  v_rcp_f32 v100, v100
  v_rcp_f32 v101, v101
  v_rcp_f32 v102, v102
  v_rcp_f32 v103, v103
  v_mul_f32 v136, v136, v100
  v_mul_f32 v137, v137, v101
  v_mul_f32 v138, v138, v102
  v_mul_f32 v139, v139, v103
  v_cvt_pk_bf16_f32 v200, v136, v137
  v_cvt_pk_bf16_f32 v201, v138, v139
  v_mul_f32 v100, v140, v140
  v_fma_f32 v100, v100, v94, v86
  v_mul_f32 v100, v100, v140
  v_mul_f32 v101, v141, v141
  v_fma_f32 v101, v101, v94, v86
  v_mul_f32 v101, v101, v141
  v_mul_f32 v102, v142, v142
  v_fma_f32 v102, v102, v94, v86
  v_mul_f32 v102, v102, v142
  v_mul_f32 v103, v143, v143
  v_fma_f32 v103, v103, v94, v86
  v_mul_f32 v103, v103, v143
  v_exp_f32 v100, v100
  v_exp_f32 v101, v101
  v_exp_f32 v102, v102
  v_exp_f32 v103, v103
  v_mul_f32 v140, v140, v172
  v_fma_f32 v100, v100, v96, v96
  v_mul_f32 v141, v141, v173
  v_fma_f32 v101, v101, v96, v96
  v_mul_f32 v142, v142, v174
  v_fma_f32 v102, v102, v96, v96
  v_mul_f32 v143, v143, v175
  v_fma_f32 v103, v103, v96, v96
  v_rcp_f32 v100, v100
  v_rcp_f32 v101, v101
  v_rcp_f32 v102, v102
  v_rcp_f32 v103, v103
  v_mul_f32 v140, v140, v100
  v_mul_f32 v141, v141, v101
  v_mul_f32 v142, v142, v102
  v_mul_f32 v143, v143, v103
  v_cvt_pk_bf16_f32 v202, v140, v141
  v_cvt_pk_bf16_f32 v203, v142, v143
  s_nop 0
  v_permlane32_swap_b32 v200, v202
  v_permlane32_swap_b32 v201, v203
  buffer_store_dwordx4 v[200:203], v112, s[20:23], s60 offen sc1
  v_mul_f32 v100, v152, v152
  v_fma_f32 v100, v100, v95, v87
  v_mul_f32 v100, v100, v152
  v_mul_f32 v101, v153, v153
  v_fma_f32 v101, v101, v95, v87
  v_mul_f32 v101, v101, v153
  v_mul_f32 v102, v154, v154
  v_fma_f32 v102, v102, v95, v87
  v_mul_f32 v102, v102, v154
  v_mul_f32 v103, v155, v155
  v_fma_f32 v103, v103, v95, v87
  v_mul_f32 v103, v103, v155
  v_exp_f32 v100, v100
  v_exp_f32 v101, v101
  v_exp_f32 v102, v102
  v_exp_f32 v103, v103
  v_mul_f32 v152, v152, v184
  v_fma_f32 v100, v100, v97, v97
  v_mul_f32 v153, v153, v185
  v_fma_f32 v101, v101, v97, v97
  v_mul_f32 v154, v154, v186
  v_fma_f32 v102, v102, v97, v97
  v_mul_f32 v155, v155, v187
  v_fma_f32 v103, v103, v97, v97
  v_rcp_f32 v100, v100
  v_rcp_f32 v101, v101
  v_rcp_f32 v102, v102
  v_rcp_f32 v103, v103
  v_mul_f32 v152, v152, v100
  v_mul_f32 v153, v153, v101
  v_mul_f32 v154, v154, v102
  v_mul_f32 v155, v155, v103
  v_cvt_pk_bf16_f32 v204, v152, v153
  v_cvt_pk_bf16_f32 v205, v154, v155
  v_mul_f32 v100, v156, v156
  v_fma_f32 v100, v100, v95, v87
  v_mul_f32 v100, v100, v156
  v_mul_f32 v101, v157, v157
  v_fma_f32 v101, v101, v95, v87
  v_mul_f32 v101, v101, v157
  v_mul_f32 v102, v158, v158
  v_fma_f32 v102, v102, v95, v87
  v_mul_f32 v102, v102, v158
  v_mul_f32 v103, v159, v159
  v_fma_f32 v103, v103, v95, v87
  v_mul_f32 v103, v103, v159
  v_exp_f32 v100, v100
  v_exp_f32 v101, v101
  v_exp_f32 v102, v102
  v_exp_f32 v103, v103
  v_mul_f32 v156, v156, v188
  v_fma_f32 v100, v100, v97, v97
  v_mul_f32 v157, v157, v189
  v_fma_f32 v101, v101, v97, v97
  v_mul_f32 v158, v158, v190
  v_fma_f32 v102, v102, v97, v97
  v_mul_f32 v159, v159, v191
  v_fma_f32 v103, v103, v97, v97
  v_rcp_f32 v100, v100
  v_rcp_f32 v101, v101
  v_rcp_f32 v102, v102
  v_rcp_f32 v103, v103
  v_mul_f32 v156, v156, v100
  v_mul_f32 v157, v157, v101
  v_mul_f32 v158, v158, v102
  v_mul_f32 v159, v159, v103
  v_cvt_pk_bf16_f32 v206, v156, v157
  v_cvt_pk_bf16_f32 v207, v158, v159
  s_nop 0
  v_permlane32_swap_b32 v204, v206
  v_permlane32_swap_b32 v205, v207
  buffer_store_dwordx4 v[204:207], v113, s[20:23], s60 offen sc1
p1_end:
  s_cmp_ge_u32 s32, 4
  s_cbranch_scc1 k_s2
  s_load_dwordx2 s[28:29], s[0:1], 56
  s_load_dwordx2 s[30:31], s[0:1], 48
  v_and_b32 v1, 63, v0
  v_and_b32 v3, 31, v0
  v_bfe_u32 v2, v0, 5, 1
  v_mov_b32 v10, 163584
  s_mov_b32 s12, s32
  s_and_b32 s13, s2, 7
  s_lshr_b32 s14, s2, 3
  s_and_b32 s15, s13, 3
  s_lshl_b32 s15, s15, 3
  s_and_b32 s39, s14, 7
  s_add_u32 s15, s15, s39
  s_lshr_b32 s13, s13, 2
  s_lshl_b32 s13, s13, 2
  s_lshr_b32 s14, s14, 3
  s_add_u32 s13, s13, s14
  s_and_b32 s36, s12, 1
  s_lshr_b32 s37, s12, 1
  v_lshrrev_b32 v24, 3, v1
  v_bfe_u32 v25, v1, 4, 1
  v_lshlrev_b32 v25, 2, v25
  v_and_b32 v26, 7, v1
  v_xor_b32 v26, v26, v25
  v_lshlrev_b32 v26, 4, v26
  v_lshl_add_u32 v11, v24, 10, v26
  s_lshl_b32 s39, s13, 7
  v_add_u32 v11, s39, v11
  v_lshl_add_u32 v5, v24, 12, v26
  s_lshl_b32 s39, s15, 7
  v_add_u32 v5, s39, v5
  s_mul_i32 s44, s12, 458752
  s_mul_i32 s45, s12, 34816
  s_mul_i32 s52, s12, 524288
  s_waitcnt lgkmcnt(0)
  s_mov_b32 s8, s30
  s_mov_b32 s9, s31
  s_mov_b32 s10, 0x1c0000
  s_mov_b32 s11, 0x20000
  s_mov_b32 s24, s6
  s_mov_b32 s25, s7
  s_mov_b32 s26, 0x200000
  s_mov_b32 s27, 0x20000
  s_mov_b32 s16, s4
  s_mov_b32 s17, s5
  s_mov_b32 s18, 0x700000
  s_mov_b32 s19, 0x20000
  s_add_u32 s20, s4, 0x700000
  s_addc_u32 s21, s5, 0
  s_mov_b32 s22, 0x202000
  s_mov_b32 s23, 0x20000
  s_mov_b32 s40, s28
  s_mov_b32 s41, s29
  s_mov_b32 s42, 0x200000
  s_mov_b32 s43, 0x20000
  s_lshl_b32 s39, s15, 1
  s_add_u32 s39, s39, s37
  s_lshl_b32 s39, s39, 10
  s_lshl_b32 s31, s13, 7
  s_add_u32 s39, s39, s31
  s_lshl_b32 s31, s36, 6
  s_add_u32 s39, s39, s31
  v_lshlrev_b32 v9, 16, v3
  v_lshl_add_u32 v9, v2, 3, v9
  v_add_u32 v9, s39, v9
  s_lshl_b32 s39, s15, 10
  v_lshlrev_b32 v4, 15, v2
  v_lshl_add_u32 v4, v3, 4, v4
  v_add_u32 v4, s39, v4
  s_mul_i32 s46, s12, 1835008
  s_mov_b32 s48, s46
  s_lshl_b32 s39, s15, 10
  v_lshlrev_b32 v8, 4, v1
  v_add_u32 v8, s39, v8
  v_lshlrev_b32 v28, 10, v2
  v_lshl_add_u32 v28, v3, 4, v28
  v_add_u32 v28, s45, v28
  s_lshl_b32 s39, s37, 9
  v_xor_b32 v29, 512, v28
  v_add_u32 v28, s39, v28
  v_subrev_u32 v29, s39, v29
  s_add_u32 s47, s46, 512
  s_sub_u32 s47, s47, s39
  s_add_u32 s46, s46, s39
  v_lshrrev_b32 v24, 5, v1
  v_lshlrev_b32 v24, 3, v24
  v_bfe_u32 v25, v1, 2, 2
  v_add_u32 v24, v24, v25
  v_lshlrev_b32 v24, 7, v24
  v_bfe_u32 v26, v1, 4, 1
  v_lshlrev_b32 v26, 1, v26
  v_bfe_u32 v27, v1, 1, 1
  v_add_u32 v26, v26, v27
  v_bfe_u32 v27, v1, 3, 1
  v_lshlrev_b32 v27, 2, v27
  v_xor_b32 v26, v26, v27
  v_lshl_add_u32 v24, v26, 4, v24
  v_and_b32 v27, 1, v1
  v_lshl_add_u32 v24, v27, 3, v24
  v_add_u32 v24, s45, v24
  s_lshl_b32 s39, s36, 6
  v_xor_b32 v12, s39, v24
  v_xor_b32 v13, 64, v12
  s_lshl_b32 s39, s37, 6
  v_xor_b32 v6, s39, v24
  v_xor_b32 v7, 64, v6
  s_lshl_b32 s39, s13, 6
  s_lshl_b32 s31, s36, 5
  s_add_u32 s39, s39, s31
  v_add_u32 v24, s39, v3
  v_cvt_f32_u32 v24, v24
  v_mul_f32 v248, 0x3b000000, v24
  s_lshl_b32 s39, s13, 6
  s_xor_b32 s31, s31, 32
  s_add_u32 s39, s39, s31
  v_add_u32 v25, s39, v3
  v_cvt_f32_u32 v25, v25
  v_mul_f32 v249, 0x3b000000, v25
  s_mul_i32 s39, s12, 64
  v_lshlrev_b32 v26, 2, v2
  v_add_u32 v26, s39, v26
  v_cvt_f32_u32 v250, v26
  s_mov_b32 s58, 0
lw_8:
  ds_read_b128 v[240:243], v10 offset:64
  s_waitcnt lgkmcnt(0)
  v_min_u32 v240, v240, v241
  v_min_u32 v242, v242, v243
  v_min_u32 v240, v240, v242
  s_nop 0
  v_readfirstlane_b32 s59, v240
  s_nop 2
  s_cmp_ge_u32 s59, 1
  s_cbranch_scc1 ld_9
  s_add_u32 s58, s58, 1
  s_cmp_lt_u32 s58, 131072
  s_cbranch_scc1 lw_8
ld_9:
  s_add_u32 m0, s45, 0
  s_add_u32 s60, s44, 0
  buffer_load_dwordx4 v11, s[8:11], s60 offen lds
  s_add_u32 m0, s45, 1024
  s_add_u32 s60, s44, 8192
  buffer_load_dwordx4 v11, s[8:11], s60 offen lds
  v_add_f32 v251, 0x00000000, v250
  v_mul_f32 v252, v251, v248
  v_fract_f32 v252, v252
  v_mul_f32 v253, v251, v249
  v_fract_f32 v253, v253
  v_cos_f32 v254, v252
  v_sin_f32 v255, v252
  s_nop 0
  v_cvt_pk_bf16_f32 v176, v254, -v255
  v_cos_f32 v254, v253
  v_sin_f32 v255, v253
  s_nop 0
  v_cvt_pk_bf16_f32 v180, v254, -v255
  s_add_u32 m0, s45, 2048
  s_add_u32 s60, s44, 16384
  buffer_load_dwordx4 v11, s[8:11], s60 offen lds
  s_add_u32 m0, s45, 3072
  s_add_u32 s60, s44, 24576
  buffer_load_dwordx4 v11, s[8:11], s60 offen lds
  v_add_f32 v251, 0x3f800000, v250
  v_mul_f32 v252, v251, v248
  v_fract_f32 v252, v252
  v_mul_f32 v253, v251, v249
  v_fract_f32 v253, v253
  v_cos_f32 v254, v252
  v_sin_f32 v255, v252
  s_nop 0
  v_cvt_pk_bf16_f32 v177, v254, -v255
  v_cos_f32 v254, v253
  v_sin_f32 v255, v253
  s_nop 0
  v_cvt_pk_bf16_f32 v181, v254, -v255
  v_add_f32 v251, 0x40000000, v250
  v_mul_f32 v252, v251, v248
  v_fract_f32 v252, v252
  v_mul_f32 v253, v251, v249
  v_fract_f32 v253, v253
  v_cos_f32 v254, v252
  v_sin_f32 v255, v252
  s_nop 0
  v_cvt_pk_bf16_f32 v178, v254, -v255
  v_cos_f32 v254, v253
  v_sin_f32 v255, v253
  s_nop 0
  v_cvt_pk_bf16_f32 v182, v254, -v255
  s_add_u32 m0, s45, 4096
  s_add_u32 s60, s44, 32768
  buffer_load_dwordx4 v11, s[8:11], s60 offen lds
  s_add_u32 m0, s45, 5120
  s_add_u32 s60, s44, 40960
  buffer_load_dwordx4 v11, s[8:11], s60 offen lds
  v_add_f32 v251, 0x40400000, v250
  v_mul_f32 v252, v251, v248
  v_fract_f32 v252, v252
  v_mul_f32 v253, v251, v249
  v_fract_f32 v253, v253
  v_cos_f32 v254, v252
  v_sin_f32 v255, v252
  s_nop 0
  v_cvt_pk_bf16_f32 v179, v254, -v255
  v_cos_f32 v254, v253
  v_sin_f32 v255, v253
  s_nop 0
  v_cvt_pk_bf16_f32 v183, v254, -v255
  v_add_f32 v251, 0x41000000, v250
  v_mul_f32 v252, v251, v248
  v_fract_f32 v252, v252
  v_mul_f32 v253, v251, v249
  v_fract_f32 v253, v253
  v_cos_f32 v254, v252
  v_sin_f32 v255, v252
  s_nop 0
  v_cvt_pk_bf16_f32 v184, v254, -v255
  v_cos_f32 v254, v253
  v_sin_f32 v255, v253
  s_nop 0
  v_cvt_pk_bf16_f32 v188, v254, -v255
  s_add_u32 m0, s45, 6144
  s_add_u32 s60, s44, 49152
  buffer_load_dwordx4 v11, s[8:11], s60 offen lds
  s_add_u32 m0, s45, 7168
  s_add_u32 s60, s44, 57344
  buffer_load_dwordx4 v11, s[8:11], s60 offen lds
  v_add_f32 v251, 0x41100000, v250
  v_mul_f32 v252, v251, v248
  v_fract_f32 v252, v252
  v_mul_f32 v253, v251, v249
  v_fract_f32 v253, v253
  v_cos_f32 v254, v252
  v_sin_f32 v255, v252
  s_nop 0
  v_cvt_pk_bf16_f32 v185, v254, -v255
  v_cos_f32 v254, v253
  v_sin_f32 v255, v253
  s_nop 0
  v_cvt_pk_bf16_f32 v189, v254, -v255
  v_add_f32 v251, 0x41200000, v250
  v_mul_f32 v252, v251, v248
  v_fract_f32 v252, v252
  v_mul_f32 v253, v251, v249
  v_fract_f32 v253, v253
  v_cos_f32 v254, v252
  v_sin_f32 v255, v252
  s_nop 0
  v_cvt_pk_bf16_f32 v186, v254, -v255
  v_cos_f32 v254, v253
  v_sin_f32 v255, v253
  s_nop 0
  v_cvt_pk_bf16_f32 v190, v254, -v255
  s_add_u32 m0, s45, 8192
  s_add_u32 s60, s44, 65536
  buffer_load_dwordx4 v11, s[8:11], s60 offen lds
  s_add_u32 m0, s45, 9216
  s_add_u32 s60, s44, 73728
  buffer_load_dwordx4 v11, s[8:11], s60 offen lds
  v_add_f32 v251, 0x41300000, v250
  v_mul_f32 v252, v251, v248
  v_fract_f32 v252, v252
  v_mul_f32 v253, v251, v249
  v_fract_f32 v253, v253
  v_cos_f32 v254, v252
  v_sin_f32 v255, v252
  s_nop 0
  v_cvt_pk_bf16_f32 v187, v254, -v255
  v_cos_f32 v254, v253
  v_sin_f32 v255, v253
  s_nop 0
  v_cvt_pk_bf16_f32 v191, v254, -v255
  v_add_f32 v251, 0x41800000, v250
  v_mul_f32 v252, v251, v248
  v_fract_f32 v252, v252
  v_mul_f32 v253, v251, v249
  v_fract_f32 v253, v253
  v_cos_f32 v254, v252
  v_sin_f32 v255, v252
  s_nop 0
  v_cvt_pk_bf16_f32 v192, v254, -v255
  v_cos_f32 v254, v253
  v_sin_f32 v255, v253
  s_nop 0
  v_cvt_pk_bf16_f32 v196, v254, -v255
  s_add_u32 m0, s45, 10240
  s_add_u32 s60, s44, 81920
  buffer_load_dwordx4 v11, s[8:11], s60 offen lds
  s_add_u32 m0, s45, 11264
  s_add_u32 s60, s44, 90112
  buffer_load_dwordx4 v11, s[8:11], s60 offen lds
  v_add_f32 v251, 0x41880000, v250
  v_mul_f32 v252, v251, v248
  v_fract_f32 v252, v252
  v_mul_f32 v253, v251, v249
  v_fract_f32 v253, v253
  v_cos_f32 v254, v252
  v_sin_f32 v255, v252
  s_nop 0
  v_cvt_pk_bf16_f32 v193, v254, -v255
  v_cos_f32 v254, v253
  v_sin_f32 v255, v253
  s_nop 0
  v_cvt_pk_bf16_f32 v197, v254, -v255
  s_add_u32 m0, s45, 12288
  s_add_u32 s60, s44, 98304
  buffer_load_dwordx4 v11, s[8:11], s60 offen lds
  s_add_u32 m0, s45, 13312
  s_add_u32 s60, s44, 106496
  buffer_load_dwordx4 v11, s[8:11], s60 offen lds
  v_add_f32 v251, 0x41900000, v250
  v_mul_f32 v252, v251, v248
  v_fract_f32 v252, v252
  v_mul_f32 v253, v251, v249
  v_fract_f32 v253, v253
  v_cos_f32 v254, v252
  v_sin_f32 v255, v252
  s_nop 0
  v_cvt_pk_bf16_f32 v194, v254, -v255
  v_cos_f32 v254, v253
  v_sin_f32 v255, v253
  s_nop 0
  v_cvt_pk_bf16_f32 v198, v254, -v255
  v_add_f32 v251, 0x41980000, v250
  v_mul_f32 v252, v251, v248
  v_fract_f32 v252, v252
  v_mul_f32 v253, v251, v249
  v_fract_f32 v253, v253
  v_cos_f32 v254, v252
  v_sin_f32 v255, v252
  s_nop 0
  v_cvt_pk_bf16_f32 v195, v254, -v255
  v_cos_f32 v254, v253
  v_sin_f32 v255, v253
  s_nop 0
  v_cvt_pk_bf16_f32 v199, v254, -v255
  s_add_u32 m0, s45, 14336
  s_add_u32 s60, s44, 114688
  buffer_load_dwordx4 v11, s[8:11], s60 offen lds
  s_add_u32 m0, s45, 15360
  s_add_u32 s60, s44, 122880
  buffer_load_dwordx4 v11, s[8:11], s60 offen lds
  v_add_f32 v251, 0x41c00000, v250
  v_mul_f32 v252, v251, v248
  v_fract_f32 v252, v252
  v_mul_f32 v253, v251, v249
  v_fract_f32 v253, v253
  v_cos_f32 v254, v252
  v_sin_f32 v255, v252
  s_nop 0
  v_cvt_pk_bf16_f32 v200, v254, -v255
  v_cos_f32 v254, v253
  v_sin_f32 v255, v253
  s_nop 0
  v_cvt_pk_bf16_f32 v204, v254, -v255
  v_add_f32 v251, 0x41c80000, v250
  v_mul_f32 v252, v251, v248
  v_fract_f32 v252, v252
  v_mul_f32 v253, v251, v249
  v_fract_f32 v253, v253
  v_cos_f32 v254, v252
  v_sin_f32 v255, v252
  s_nop 0
  v_cvt_pk_bf16_f32 v201, v254, -v255
  v_cos_f32 v254, v253
  v_sin_f32 v255, v253
  s_nop 0
  v_cvt_pk_bf16_f32 v205, v254, -v255
  s_add_u32 m0, s45, 16384
  s_add_u32 s60, s44, 131072
  buffer_load_dwordx4 v11, s[8:11], s60 offen lds
  s_add_u32 m0, s45, 17408
  s_add_u32 s60, s44, 139264
  buffer_load_dwordx4 v11, s[8:11], s60 offen lds
  v_add_f32 v251, 0x41d00000, v250
  v_mul_f32 v252, v251, v248
  v_fract_f32 v252, v252
  v_mul_f32 v253, v251, v249
  v_fract_f32 v253, v253
  v_cos_f32 v254, v252
  v_sin_f32 v255, v252
  s_nop 0
  v_cvt_pk_bf16_f32 v202, v254, -v255
  v_cos_f32 v254, v253
  v_sin_f32 v255, v253
  s_nop 0
  v_cvt_pk_bf16_f32 v206, v254, -v255
  v_add_f32 v251, 0x41d80000, v250
  v_mul_f32 v252, v251, v248
  v_fract_f32 v252, v252
  v_mul_f32 v253, v251, v249
  v_fract_f32 v253, v253
  v_cos_f32 v254, v252
  v_sin_f32 v255, v252
  s_nop 0
  v_cvt_pk_bf16_f32 v203, v254, -v255
  v_cos_f32 v254, v253
  v_sin_f32 v255, v253
  s_nop 0
  v_cvt_pk_bf16_f32 v207, v254, -v255
  s_add_u32 m0, s45, 18432
  s_add_u32 s60, s44, 147456
  buffer_load_dwordx4 v11, s[8:11], s60 offen lds
  s_add_u32 m0, s45, 19456
  s_add_u32 s60, s44, 155648
  buffer_load_dwordx4 v11, s[8:11], s60 offen lds
  v_add_f32 v251, 0x42000000, v250
  v_mul_f32 v252, v251, v248
  v_fract_f32 v252, v252
  v_mul_f32 v253, v251, v249
  v_fract_f32 v253, v253
  v_cos_f32 v254, v252
  v_sin_f32 v255, v252
  s_nop 0
  v_cvt_pk_bf16_f32 v208, v254, -v255
  v_cos_f32 v254, v253
  v_sin_f32 v255, v253
  s_nop 0
  v_cvt_pk_bf16_f32 v212, v254, -v255
  v_add_f32 v251, 0x42040000, v250
  v_mul_f32 v252, v251, v248
  v_fract_f32 v252, v252
  v_mul_f32 v253, v251, v249
  v_fract_f32 v253, v253
  v_cos_f32 v254, v252
  v_sin_f32 v255, v252
  s_nop 0
  v_cvt_pk_bf16_f32 v209, v254, -v255
  v_cos_f32 v254, v253
  v_sin_f32 v255, v253
  s_nop 0
  v_cvt_pk_bf16_f32 v213, v254, -v255
  s_add_u32 m0, s45, 20480
  s_add_u32 s60, s44, 163840
  buffer_load_dwordx4 v11, s[8:11], s60 offen lds
  s_add_u32 m0, s45, 21504
  s_add_u32 s60, s44, 172032
  buffer_load_dwordx4 v11, s[8:11], s60 offen lds
  v_add_f32 v251, 0x42080000, v250
  v_mul_f32 v252, v251, v248
  v_fract_f32 v252, v252
  v_mul_f32 v253, v251, v249
  v_fract_f32 v253, v253
  v_cos_f32 v254, v252
  v_sin_f32 v255, v252
  s_nop 0
  v_cvt_pk_bf16_f32 v210, v254, -v255
  v_cos_f32 v254, v253
  v_sin_f32 v255, v253
  s_nop 0
  v_cvt_pk_bf16_f32 v214, v254, -v255
  v_add_f32 v251, 0x420c0000, v250
  v_mul_f32 v252, v251, v248
  v_fract_f32 v252, v252
  v_mul_f32 v253, v251, v249
  v_fract_f32 v253, v253
  v_cos_f32 v254, v252
  v_sin_f32 v255, v252
  s_nop 0
  v_cvt_pk_bf16_f32 v211, v254, -v255
  v_cos_f32 v254, v253
  v_sin_f32 v255, v253
  s_nop 0
  v_cvt_pk_bf16_f32 v215, v254, -v255
  s_waitcnt vmcnt(22)
  s_barrier
  s_cmp_lg_u32 s32, 0
  s_cbranch_scc1 p3_a1
  s_add_u32 s59, s35, 32
  s_mov_b32 s61, s59
  s_add_u32 s62, s4, 0x1000000
  s_addc_u32 s63, s5, 0
  s_lshl_b32 s59, s61, 7
  v_mov_b32 v24, s59
  v_mov_b32 v25, 1
  s_mov_b64 exec, 1
  global_atomic_add v24, v25, s[62:63] sc1
  s_mov_b64 exec, -1
p3_a1:
  s_add_u32 m0, s45, 22528
  s_add_u32 s60, s44, 180224
  buffer_load_dwordx4 v11, s[8:11], s60 offen lds
  s_add_u32 m0, s45, 23552
  s_add_u32 s60, s44, 188416
  buffer_load_dwordx4 v11, s[8:11], s60 offen lds
  v_add_f32 v251, 0x42200000, v250
  v_mul_f32 v252, v251, v248
  v_fract_f32 v252, v252
  v_mul_f32 v253, v251, v249
  v_fract_f32 v253, v253
  v_cos_f32 v254, v252
  v_sin_f32 v255, v252
  s_nop 0
  v_cvt_pk_bf16_f32 v216, v254, -v255
  v_cos_f32 v254, v253
  v_sin_f32 v255, v253
  s_nop 0
  v_cvt_pk_bf16_f32 v220, v254, -v255
  v_add_f32 v251, 0x42240000, v250
  v_mul_f32 v252, v251, v248
  v_fract_f32 v252, v252
  v_mul_f32 v253, v251, v249
  v_fract_f32 v253, v253
  v_cos_f32 v254, v252
  v_sin_f32 v255, v252
  s_nop 0
  v_cvt_pk_bf16_f32 v217, v254, -v255
  v_cos_f32 v254, v253
  v_sin_f32 v255, v253
  s_nop 0
  v_cvt_pk_bf16_f32 v221, v254, -v255
  s_add_u32 m0, s45, 24576
  s_add_u32 s60, s44, 196608
  buffer_load_dwordx4 v11, s[8:11], s60 offen lds
  s_add_u32 m0, s45, 25600
  s_add_u32 s60, s44, 204800
  buffer_load_dwordx4 v11, s[8:11], s60 offen lds
  v_add_f32 v251, 0x42280000, v250
  v_mul_f32 v252, v251, v248
  v_fract_f32 v252, v252
  v_mul_f32 v253, v251, v249
  v_fract_f32 v253, v253
  v_cos_f32 v254, v252
  v_sin_f32 v255, v252
  s_nop 0
  v_cvt_pk_bf16_f32 v218, v254, -v255
  v_cos_f32 v254, v253
  v_sin_f32 v255, v253
  s_nop 0
  v_cvt_pk_bf16_f32 v222, v254, -v255
  v_add_f32 v251, 0x422c0000, v250
  v_mul_f32 v252, v251, v248
  v_fract_f32 v252, v252
  v_mul_f32 v253, v251, v249
  v_fract_f32 v253, v253
  v_cos_f32 v254, v252
  v_sin_f32 v255, v252
  s_nop 0
  v_cvt_pk_bf16_f32 v219, v254, -v255
  v_cos_f32 v254, v253
  v_sin_f32 v255, v253
  s_nop 0
  v_cvt_pk_bf16_f32 v223, v254, -v255
  s_add_u32 m0, s45, 26624
  s_add_u32 s60, s44, 212992
  buffer_load_dwordx4 v11, s[8:11], s60 offen lds
  s_add_u32 m0, s45, 27648
  s_add_u32 s60, s44, 221184
  buffer_load_dwordx4 v11, s[8:11], s60 offen lds
  v_add_f32 v251, 0x42400000, v250
  v_mul_f32 v252, v251, v248
  v_fract_f32 v252, v252
  v_mul_f32 v253, v251, v249
  v_fract_f32 v253, v253
  v_cos_f32 v254, v252
  v_sin_f32 v255, v252
  s_nop 0
  v_cvt_pk_bf16_f32 v224, v254, -v255
  v_cos_f32 v254, v253
  v_sin_f32 v255, v253
  s_nop 0
  v_cvt_pk_bf16_f32 v228, v254, -v255
  v_add_f32 v251, 0x42440000, v250
  v_mul_f32 v252, v251, v248
  v_fract_f32 v252, v252
  v_mul_f32 v253, v251, v249
  v_fract_f32 v253, v253
  v_cos_f32 v254, v252
  v_sin_f32 v255, v252
  s_nop 0
  v_cvt_pk_bf16_f32 v225, v254, -v255
  v_cos_f32 v254, v253
  v_sin_f32 v255, v253
  s_nop 0
  v_cvt_pk_bf16_f32 v229, v254, -v255
  s_add_u32 m0, s45, 28672
  s_add_u32 s60, s44, 229376
  buffer_load_dwordx4 v11, s[8:11], s60 offen lds
  s_add_u32 m0, s45, 29696
  s_add_u32 s60, s44, 237568
  buffer_load_dwordx4 v11, s[8:11], s60 offen lds
  v_add_f32 v251, 0x42480000, v250
  v_mul_f32 v252, v251, v248
  v_fract_f32 v252, v252
  v_mul_f32 v253, v251, v249
  v_fract_f32 v253, v253
  v_cos_f32 v254, v252
  v_sin_f32 v255, v252
  s_nop 0
  v_cvt_pk_bf16_f32 v226, v254, -v255
  v_cos_f32 v254, v253
  v_sin_f32 v255, v253
  s_nop 0
  v_cvt_pk_bf16_f32 v230, v254, -v255
  v_add_f32 v251, 0x424c0000, v250
  v_mul_f32 v252, v251, v248
  v_fract_f32 v252, v252
  v_mul_f32 v253, v251, v249
  v_fract_f32 v253, v253
  v_cos_f32 v254, v252
  v_sin_f32 v255, v252
  s_nop 0
  v_cvt_pk_bf16_f32 v227, v254, -v255
  v_cos_f32 v254, v253
  v_sin_f32 v255, v253
  s_nop 0
  v_cvt_pk_bf16_f32 v231, v254, -v255
  s_add_u32 m0, s45, 30720
  s_add_u32 s60, s44, 245760
  buffer_load_dwordx4 v11, s[8:11], s60 offen lds
  s_add_u32 m0, s45, 31744
  s_add_u32 s60, s44, 253952
  buffer_load_dwordx4 v11, s[8:11], s60 offen lds
  v_add_f32 v251, 0x42600000, v250
  v_mul_f32 v252, v251, v248
  v_fract_f32 v252, v252
  v_mul_f32 v253, v251, v249
  v_fract_f32 v253, v253
  v_cos_f32 v254, v252
  v_sin_f32 v255, v252
  s_nop 0
  v_cvt_pk_bf16_f32 v232, v254, -v255
  v_cos_f32 v254, v253
  v_sin_f32 v255, v253
  s_nop 0
  v_cvt_pk_bf16_f32 v236, v254, -v255
  v_add_f32 v251, 0x42640000, v250
  v_mul_f32 v252, v251, v248
  v_fract_f32 v252, v252
  v_mul_f32 v253, v251, v249
  v_fract_f32 v253, v253
  v_cos_f32 v254, v252
  v_sin_f32 v255, v252
  s_nop 0
  v_cvt_pk_bf16_f32 v233, v254, -v255
  v_cos_f32 v254, v253
  v_sin_f32 v255, v253
  s_nop 0
  v_cvt_pk_bf16_f32 v237, v254, -v255
  s_add_u32 m0, s45, 32768
  s_add_u32 s60, s44, 262144
  buffer_load_dwordx4 v11, s[8:11], s60 offen lds
  s_add_u32 m0, s45, 33792
  s_add_u32 s60, s44, 270336
  buffer_load_dwordx4 v11, s[8:11], s60 offen lds
  v_add_f32 v251, 0x42680000, v250
  v_mul_f32 v252, v251, v248
  v_fract_f32 v252, v252
  v_mul_f32 v253, v251, v249
  v_fract_f32 v253, v253
  v_cos_f32 v254, v252
  v_sin_f32 v255, v252
  s_nop 0
  v_cvt_pk_bf16_f32 v234, v254, -v255
  v_cos_f32 v254, v253
  v_sin_f32 v255, v253
  s_nop 0
  v_cvt_pk_bf16_f32 v238, v254, -v255
  v_add_f32 v251, 0x426c0000, v250
  v_mul_f32 v252, v251, v248
  v_fract_f32 v252, v252
  v_mul_f32 v253, v251, v249
  v_fract_f32 v253, v253
  v_cos_f32 v254, v252
  v_sin_f32 v255, v252
  s_nop 0
  v_cvt_pk_bf16_f32 v235, v254, -v255
  v_cos_f32 v254, v253
  v_sin_f32 v255, v253
  s_nop 0
  v_cvt_pk_bf16_f32 v239, v254, -v255
  s_lshr_b32 s59, s15, 1
  s_add_u32 s59, s59, 32
  s_lshl_b32 s59, s59, 7
  v_mov_b32 v24, s59
  v_mov_b32 v25, 16
  s_cmp_lg_u32 s32, 0
  s_cbranch_scc1 p3_w1
  s_add_u32 s62, s4, 0x1000000
  s_addc_u32 s63, s5, 0
  s_mov_b32 s58, 0
  s_mov_b64 exec, 1
pc_10:
  global_load_dword v26, v24, s[62:63] sc1
  s_waitcnt vmcnt(0)
pk_12:
  v_cmp_ne_u32 vcc, v26, v25
  s_cbranch_vccz pd_11
  s_add_u32 s58, s58, 1
  s_cmp_lt_u32 s58, 8192
  s_cbranch_scc1 pc_10
pd_11:
  s_mov_b64 exec, -1
  v_mov_b32 v24, 1
  ds_write_b32 v10, v24
p3_w1:
  s_mov_b32 s58, 0
lw_13:
  ds_read_b32 v24, v10 offset:0
  s_waitcnt lgkmcnt(0)
  v_readfirstlane_b32 s59, v24
  s_nop 2
  s_cmp_ge_u32 s59, 1
  s_cbranch_scc1 ld_14
  s_add_u32 s58, s58, 1
  s_cmp_lt_u32 s58, 131072
  s_cbranch_scc1 lw_13
ld_14:
  buffer_load_dwordx4 v[112:115], v4, s[16:19], s46 offen sc1
  buffer_load_dwordx4 v[116:119], v4, s[16:19], s47 offen sc1
  s_add_u32 s46, s46, 65536
  s_add_u32 s47, s47, 65536
  s_add_u32 s48, s48, 65536
  buffer_load_dwordx4 v[120:123], v4, s[16:19], s46 offen sc1
  buffer_load_dwordx4 v[124:127], v4, s[16:19], s47 offen sc1
  s_add_u32 s46, s46, 65536
  s_add_u32 s47, s47, 65536
  s_add_u32 s48, s48, 65536
  buffer_load_dwordx4 v[128:131], v4, s[16:19], s46 offen sc1
  buffer_load_dwordx4 v[132:135], v4, s[16:19], s47 offen sc1
  s_add_u32 s46, s46, 65536
  s_add_u32 s47, s47, 65536
  s_add_u32 s48, s48, 65536
  buffer_load_dwordx4 v[136:139], v4, s[16:19], s46 offen sc1
  buffer_load_dwordx4 v[140:143], v4, s[16:19], s47 offen sc1
  s_add_u32 s46, s46, 65536
  s_add_u32 s47, s47, 65536
  s_add_u32 s48, s48, 65536
  buffer_load_dwordx4 v[144:147], v4, s[16:19], s46 offen sc1
  buffer_load_dwordx4 v[148:151], v4, s[16:19], s47 offen sc1
  s_add_u32 s46, s46, 65536
  s_add_u32 s47, s47, 65536
  s_add_u32 s48, s48, 65536
  buffer_load_dwordx4 v[152:155], v4, s[16:19], s46 offen sc1
  buffer_load_dwordx4 v[156:159], v4, s[16:19], s47 offen sc1
  s_add_u32 s46, s46, 65536
  s_add_u32 s47, s47, 65536
  s_add_u32 s48, s48, 65536
  buffer_load_dwordx4 v[160:163], v4, s[16:19], s46 offen sc1
  buffer_load_dwordx4 v[164:167], v4, s[16:19], s47 offen sc1
  s_add_u32 s46, s46, 65536
  s_add_u32 s47, s47, 65536
  s_add_u32 s48, s48, 65536
  buffer_load_dwordx4 v[168:171], v4, s[16:19], s46 offen sc1
  buffer_load_dwordx4 v[172:175], v4, s[16:19], s47 offen sc1
  s_add_u32 s46, s46, 65536
  s_add_u32 s47, s47, 65536
  s_add_u32 s48, s48, 65536
  s_waitcnt vmcnt(48)
  ds_read_b64_tr_b16 v[96:97], v12 offset:0
  ds_read_b64_tr_b16 v[98:99], v12 offset:512
  ds_read_b64_tr_b16 v[100:101], v13 offset:0
  ds_read_b64_tr_b16 v[102:103], v13 offset:512
  s_waitcnt vmcnt(14)
  s_waitcnt lgkmcnt(0)
  ds_read_b64_tr_b16 v[104:105], v12 offset:2048
  ds_read_b64_tr_b16 v[106:107], v12 offset:2560
  ds_read_b64_tr_b16 v[108:109], v13 offset:2048
  ds_read_b64_tr_b16 v[110:111], v13 offset:2560
  v_mfma_f32_32x32x16_bf16 v[32:47], v[96:99], v[112:115], 0
  v_mfma_f32_32x32x16_bf16 v[48:63], v[100:103], v[112:115], 0
  v_mfma_f32_32x32x16_bf16 v[64:79], v[96:99], v[116:119], 0
  v_mfma_f32_32x32x16_bf16 v[80:95], v[100:103], v[116:119], 0
  s_add_u32 m0, s45, 0
  s_add_u32 s60, s44, 278528
  buffer_load_dwordx4 v11, s[8:11], s60 offen lds
  s_add_u32 m0, s45, 1024
  s_add_u32 s60, s44, 286720
  buffer_load_dwordx4 v11, s[8:11], s60 offen lds
  buffer_load_dwordx4 v[112:115], v4, s[16:19], s46 offen sc1
  buffer_load_dwordx4 v[116:119], v4, s[16:19], s47 offen sc1
  s_add_u32 s46, s46, 65536
  s_add_u32 s47, s47, 65536
  s_add_u32 s48, s48, 65536
  s_waitcnt vmcnt(16)
  s_waitcnt lgkmcnt(0)
  ds_read_b64_tr_b16 v[96:97], v12 offset:4096
  ds_read_b64_tr_b16 v[98:99], v12 offset:4608
  ds_read_b64_tr_b16 v[100:101], v13 offset:4096
  ds_read_b64_tr_b16 v[102:103], v13 offset:4608
  v_mfma_f32_32x32x16_bf16 v[32:47], v[104:107], v[120:123], v[32:47]
  v_mfma_f32_32x32x16_bf16 v[48:63], v[108:111], v[120:123], v[48:63]
  v_mfma_f32_32x32x16_bf16 v[64:79], v[104:107], v[124:127], v[64:79]
  v_mfma_f32_32x32x16_bf16 v[80:95], v[108:111], v[124:127], v[80:95]
  s_add_u32 m0, s45, 2048
  s_add_u32 s60, s44, 294912
  buffer_load_dwordx4 v11, s[8:11], s60 offen lds
  s_add_u32 m0, s45, 3072
  s_add_u32 s60, s44, 303104
  buffer_load_dwordx4 v11, s[8:11], s60 offen lds
  buffer_load_dwordx4 v[120:123], v4, s[16:19], s46 offen sc1
  buffer_load_dwordx4 v[124:127], v4, s[16:19], s47 offen sc1
  s_add_u32 s46, s46, 65536
  s_add_u32 s47, s47, 65536
  s_add_u32 s48, s48, 65536
  s_waitcnt vmcnt(18)
  s_waitcnt lgkmcnt(0)
  ds_read_b64_tr_b16 v[104:105], v12 offset:6144
  ds_read_b64_tr_b16 v[106:107], v12 offset:6656
  ds_read_b64_tr_b16 v[108:109], v13 offset:6144
  ds_read_b64_tr_b16 v[110:111], v13 offset:6656
  v_mfma_f32_32x32x16_bf16 v[32:47], v[96:99], v[128:131], v[32:47]
  v_mfma_f32_32x32x16_bf16 v[48:63], v[100:103], v[128:131], v[48:63]
  v_mfma_f32_32x32x16_bf16 v[64:79], v[96:99], v[132:135], v[64:79]
  v_mfma_f32_32x32x16_bf16 v[80:95], v[100:103], v[132:135], v[80:95]
  s_add_u32 m0, s45, 4096
  s_add_u32 s60, s44, 311296
  buffer_load_dwordx4 v11, s[8:11], s60 offen lds
  s_add_u32 m0, s45, 5120
  s_add_u32 s60, s44, 319488
  buffer_load_dwordx4 v11, s[8:11], s60 offen lds
  buffer_load_dwordx4 v[128:131], v4, s[16:19], s46 offen sc1
  buffer_load_dwordx4 v[132:135], v4, s[16:19], s47 offen sc1
  s_add_u32 s46, s46, 65536
  s_add_u32 s47, s47, 65536
  s_add_u32 s48, s48, 65536
  s_waitcnt vmcnt(20)
  s_waitcnt lgkmcnt(0)
  ds_read_b64_tr_b16 v[96:97], v12 offset:8192
  ds_read_b64_tr_b16 v[98:99], v12 offset:8704
  ds_read_b64_tr_b16 v[100:101], v13 offset:8192
  ds_read_b64_tr_b16 v[102:103], v13 offset:8704
  v_mfma_f32_32x32x16_bf16 v[32:47], v[104:107], v[136:139], v[32:47]
  v_mfma_f32_32x32x16_bf16 v[48:63], v[108:111], v[136:139], v[48:63]
  v_mfma_f32_32x32x16_bf16 v[64:79], v[104:107], v[140:143], v[64:79]
  v_mfma_f32_32x32x16_bf16 v[80:95], v[108:111], v[140:143], v[80:95]
  s_add_u32 m0, s45, 6144
  s_add_u32 s60, s44, 327680
  buffer_load_dwordx4 v11, s[8:11], s60 offen lds
  s_add_u32 m0, s45, 7168
  s_add_u32 s60, s44, 335872
  buffer_load_dwordx4 v11, s[8:11], s60 offen lds
  buffer_load_dwordx4 v[136:139], v4, s[16:19], s46 offen sc1
  buffer_load_dwordx4 v[140:143], v4, s[16:19], s47 offen sc1
  s_add_u32 s46, s46, 65536
  s_add_u32 s47, s47, 65536
  s_add_u32 s48, s48, 65536
  s_waitcnt vmcnt(22)
  s_waitcnt lgkmcnt(0)
  ds_read_b64_tr_b16 v[104:105], v12 offset:10240
  ds_read_b64_tr_b16 v[106:107], v12 offset:10752
  ds_read_b64_tr_b16 v[108:109], v13 offset:10240
  ds_read_b64_tr_b16 v[110:111], v13 offset:10752
  v_mfma_f32_32x32x16_bf16 v[32:47], v[96:99], v[144:147], v[32:47]
  v_mfma_f32_32x32x16_bf16 v[48:63], v[100:103], v[144:147], v[48:63]
  v_mfma_f32_32x32x16_bf16 v[64:79], v[96:99], v[148:151], v[64:79]
  v_mfma_f32_32x32x16_bf16 v[80:95], v[100:103], v[148:151], v[80:95]
  s_add_u32 m0, s45, 8192
  s_add_u32 s60, s44, 344064
  buffer_load_dwordx4 v11, s[8:11], s60 offen lds
  s_add_u32 m0, s45, 9216
  s_add_u32 s60, s44, 352256
  buffer_load_dwordx4 v11, s[8:11], s60 offen lds
  buffer_load_dwordx4 v[144:147], v4, s[16:19], s46 offen sc1
  buffer_load_dwordx4 v[148:151], v4, s[16:19], s47 offen sc1
  s_add_u32 s46, s46, 65536
  s_add_u32 s47, s47, 65536
  s_add_u32 s48, s48, 65536
  s_waitcnt vmcnt(24)
  s_waitcnt lgkmcnt(0)
  ds_read_b64_tr_b16 v[96:97], v12 offset:12288
  ds_read_b64_tr_b16 v[98:99], v12 offset:12800
  ds_read_b64_tr_b16 v[100:101], v13 offset:12288
  ds_read_b64_tr_b16 v[102:103], v13 offset:12800
  v_mfma_f32_32x32x16_bf16 v[32:47], v[104:107], v[152:155], v[32:47]
  v_mfma_f32_32x32x16_bf16 v[48:63], v[108:111], v[152:155], v[48:63]
  v_mfma_f32_32x32x16_bf16 v[64:79], v[104:107], v[156:159], v[64:79]
  v_mfma_f32_32x32x16_bf16 v[80:95], v[108:111], v[156:159], v[80:95]
  s_add_u32 m0, s45, 10240
  s_add_u32 s60, s44, 360448
  buffer_load_dwordx4 v11, s[8:11], s60 offen lds
  s_add_u32 m0, s45, 11264
  s_add_u32 s60, s44, 368640
  buffer_load_dwordx4 v11, s[8:11], s60 offen lds
  buffer_load_dwordx4 v[152:155], v4, s[16:19], s46 offen sc1
  buffer_load_dwordx4 v[156:159], v4, s[16:19], s47 offen sc1
  s_add_u32 s46, s46, 65536
  s_add_u32 s47, s47, 65536
  s_add_u32 s48, s48, 65536
  s_waitcnt vmcnt(26)
  s_waitcnt lgkmcnt(0)
  ds_read_b64_tr_b16 v[104:105], v12 offset:14336
  ds_read_b64_tr_b16 v[106:107], v12 offset:14848
  ds_read_b64_tr_b16 v[108:109], v13 offset:14336
  ds_read_b64_tr_b16 v[110:111], v13 offset:14848
  v_mfma_f32_32x32x16_bf16 v[32:47], v[96:99], v[160:163], v[32:47]
  v_mfma_f32_32x32x16_bf16 v[48:63], v[100:103], v[160:163], v[48:63]
  v_mfma_f32_32x32x16_bf16 v[64:79], v[96:99], v[164:167], v[64:79]
  v_mfma_f32_32x32x16_bf16 v[80:95], v[100:103], v[164:167], v[80:95]
  s_add_u32 m0, s45, 12288
  s_add_u32 s60, s44, 376832
  buffer_load_dwordx4 v11, s[8:11], s60 offen lds
  s_add_u32 m0, s45, 13312
  s_add_u32 s60, s44, 385024
  buffer_load_dwordx4 v11, s[8:11], s60 offen lds
  buffer_load_dwordx4 v[160:163], v4, s[16:19], s46 offen sc1
  buffer_load_dwordx4 v[164:167], v4, s[16:19], s47 offen sc1
  s_add_u32 s46, s46, 65536
  s_add_u32 s47, s47, 65536
  s_add_u32 s48, s48, 65536
  s_waitcnt vmcnt(28)
  s_waitcnt lgkmcnt(0)
  ds_read_b64_tr_b16 v[96:97], v12 offset:16384
  ds_read_b64_tr_b16 v[98:99], v12 offset:16896
  ds_read_b64_tr_b16 v[100:101], v13 offset:16384
  ds_read_b64_tr_b16 v[102:103], v13 offset:16896
  v_mfma_f32_32x32x16_bf16 v[32:47], v[104:107], v[168:171], v[32:47]
  v_mfma_f32_32x32x16_bf16 v[48:63], v[108:111], v[168:171], v[48:63]
  v_mfma_f32_32x32x16_bf16 v[64:79], v[104:107], v[172:175], v[64:79]
  v_mfma_f32_32x32x16_bf16 v[80:95], v[108:111], v[172:175], v[80:95]
  s_add_u32 m0, s45, 14336
  s_add_u32 s60, s44, 393216
  buffer_load_dwordx4 v11, s[8:11], s60 offen lds
  s_add_u32 m0, s45, 15360
  s_add_u32 s60, s44, 401408
  buffer_load_dwordx4 v11, s[8:11], s60 offen lds
  buffer_load_dwordx4 v[168:171], v4, s[16:19], s46 offen sc1
  buffer_load_dwordx4 v[172:175], v4, s[16:19], s47 offen sc1
  s_add_u32 s46, s46, 65536
  s_add_u32 s47, s47, 65536
  s_add_u32 s48, s48, 65536
  s_waitcnt vmcnt(28)
  s_waitcnt lgkmcnt(0)
  ds_read_b64_tr_b16 v[104:105], v12 offset:18432
  ds_read_b64_tr_b16 v[106:107], v12 offset:18944
  ds_read_b64_tr_b16 v[108:109], v13 offset:18432
  ds_read_b64_tr_b16 v[110:111], v13 offset:18944
  v_mfma_f32_32x32x16_bf16 v[32:47], v[96:99], v[112:115], v[32:47]
  v_mfma_f32_32x32x16_bf16 v[48:63], v[100:103], v[112:115], v[48:63]
  v_mfma_f32_32x32x16_bf16 v[64:79], v[96:99], v[116:119], v[64:79]
  v_mfma_f32_32x32x16_bf16 v[80:95], v[100:103], v[116:119], v[80:95]
  s_add_u32 m0, s45, 16384
  s_add_u32 s60, s44, 409600
  buffer_load_dwordx4 v11, s[8:11], s60 offen lds
  s_add_u32 m0, s45, 17408
  s_add_u32 s60, s44, 417792
  buffer_load_dwordx4 v11, s[8:11], s60 offen lds
  buffer_load_dwordx4 v[112:115], v4, s[16:19], s46 offen sc1
  buffer_load_dwordx4 v[116:119], v4, s[16:19], s47 offen sc1
  s_add_u32 s46, s46, 65536
  s_add_u32 s47, s47, 65536
  s_add_u32 s48, s48, 65536
  s_waitcnt vmcnt(28)
  s_waitcnt lgkmcnt(0)
  ds_read_b64_tr_b16 v[96:97], v12 offset:20480
  ds_read_b64_tr_b16 v[98:99], v12 offset:20992
  ds_read_b64_tr_b16 v[100:101], v13 offset:20480
  ds_read_b64_tr_b16 v[102:103], v13 offset:20992
  v_mfma_f32_32x32x16_bf16 v[32:47], v[104:107], v[120:123], v[32:47]
  v_mfma_f32_32x32x16_bf16 v[48:63], v[108:111], v[120:123], v[48:63]
  v_mfma_f32_32x32x16_bf16 v[64:79], v[104:107], v[124:127], v[64:79]
  v_mfma_f32_32x32x16_bf16 v[80:95], v[108:111], v[124:127], v[80:95]
  s_add_u32 m0, s45, 18432
  s_add_u32 s60, s44, 425984
  buffer_load_dwordx4 v11, s[8:11], s60 offen lds
  s_add_u32 m0, s45, 19456
  s_add_u32 s60, s44, 434176
  buffer_load_dwordx4 v11, s[8:11], s60 offen lds
  buffer_load_dwordx4 v[120:123], v4, s[16:19], s46 offen sc1
  buffer_load_dwordx4 v[124:127], v4, s[16:19], s47 offen sc1
  s_add_u32 s46, s46, 65536
  s_add_u32 s47, s47, 65536
  s_add_u32 s48, s48, 65536
  s_waitcnt vmcnt(28)
  s_waitcnt lgkmcnt(0)
  ds_read_b64_tr_b16 v[104:105], v12 offset:22528
  ds_read_b64_tr_b16 v[106:107], v12 offset:23040
  ds_read_b64_tr_b16 v[108:109], v13 offset:22528
  ds_read_b64_tr_b16 v[110:111], v13 offset:23040
  v_mfma_f32_32x32x16_bf16 v[32:47], v[96:99], v[128:131], v[32:47]
  v_mfma_f32_32x32x16_bf16 v[48:63], v[100:103], v[128:131], v[48:63]
  v_mfma_f32_32x32x16_bf16 v[64:79], v[96:99], v[132:135], v[64:79]
  v_mfma_f32_32x32x16_bf16 v[80:95], v[100:103], v[132:135], v[80:95]
  s_add_u32 m0, s45, 20480
  s_add_u32 s60, s44, 442368
  buffer_load_dwordx4 v11, s[8:11], s60 offen lds
  s_add_u32 m0, s45, 21504
  s_add_u32 s60, s44, 450560
  buffer_load_dwordx4 v11, s[8:11], s60 offen lds
  buffer_load_dwordx4 v[128:131], v4, s[16:19], s46 offen sc1
  buffer_load_dwordx4 v[132:135], v4, s[16:19], s47 offen sc1
  s_add_u32 s46, s46, 65536
  s_add_u32 s47, s47, 65536
  s_add_u32 s48, s48, 65536
  s_waitcnt vmcnt(28)
  s_waitcnt lgkmcnt(0)
  ds_read_b64_tr_b16 v[96:97], v12 offset:24576
  ds_read_b64_tr_b16 v[98:99], v12 offset:25088
  ds_read_b64_tr_b16 v[100:101], v13 offset:24576
  ds_read_b64_tr_b16 v[102:103], v13 offset:25088
  v_mfma_f32_32x32x16_bf16 v[32:47], v[104:107], v[136:139], v[32:47]
  v_mfma_f32_32x32x16_bf16 v[48:63], v[108:111], v[136:139], v[48:63]
  v_mfma_f32_32x32x16_bf16 v[64:79], v[104:107], v[140:143], v[64:79]
  v_mfma_f32_32x32x16_bf16 v[80:95], v[108:111], v[140:143], v[80:95]
  buffer_load_dwordx4 v[136:139], v4, s[16:19], s46 offen sc1
  buffer_load_dwordx4 v[140:143], v4, s[16:19], s47 offen sc1
  s_add_u32 s46, s46, 65536
  s_add_u32 s47, s47, 65536
  s_add_u32 s48, s48, 65536
  s_waitcnt vmcnt(26)
  s_waitcnt lgkmcnt(0)
  ds_read_b64_tr_b16 v[104:105], v12 offset:26624
  ds_read_b64_tr_b16 v[106:107], v12 offset:27136
  ds_read_b64_tr_b16 v[108:109], v13 offset:26624
  ds_read_b64_tr_b16 v[110:111], v13 offset:27136
  v_mfma_f32_32x32x16_bf16 v[32:47], v[96:99], v[144:147], v[32:47]
  v_mfma_f32_32x32x16_bf16 v[48:63], v[100:103], v[144:147], v[48:63]
  v_mfma_f32_32x32x16_bf16 v[64:79], v[96:99], v[148:151], v[64:79]
  v_mfma_f32_32x32x16_bf16 v[80:95], v[100:103], v[148:151], v[80:95]
  buffer_load_dwordx4 v[144:147], v4, s[16:19], s46 offen sc1
  buffer_load_dwordx4 v[148:151], v4, s[16:19], s47 offen sc1
  s_add_u32 s46, s46, 65536
  s_add_u32 s47, s47, 65536
  s_add_u32 s48, s48, 65536
  s_waitcnt vmcnt(24)
  s_waitcnt lgkmcnt(0)
  ds_read_b64_tr_b16 v[96:97], v12 offset:28672
  ds_read_b64_tr_b16 v[98:99], v12 offset:29184
  ds_read_b64_tr_b16 v[100:101], v13 offset:28672
  ds_read_b64_tr_b16 v[102:103], v13 offset:29184
  v_mfma_f32_32x32x16_bf16 v[32:47], v[104:107], v[152:155], v[32:47]
  v_mfma_f32_32x32x16_bf16 v[48:63], v[108:111], v[152:155], v[48:63]
  v_mfma_f32_32x32x16_bf16 v[64:79], v[104:107], v[156:159], v[64:79]
  v_mfma_f32_32x32x16_bf16 v[80:95], v[108:111], v[156:159], v[80:95]
  buffer_load_dwordx4 v[152:155], v4, s[16:19], s46 offen sc1
  buffer_load_dwordx4 v[156:159], v4, s[16:19], s47 offen sc1
  s_add_u32 s46, s46, 65536
  s_add_u32 s47, s47, 65536
  s_add_u32 s48, s48, 65536
  s_waitcnt vmcnt(22)
  s_waitcnt lgkmcnt(0)
  ds_read_b64_tr_b16 v[104:105], v12 offset:30720
  ds_read_b64_tr_b16 v[106:107], v12 offset:31232
  ds_read_b64_tr_b16 v[108:109], v13 offset:30720
  ds_read_b64_tr_b16 v[110:111], v13 offset:31232
  v_mfma_f32_32x32x16_bf16 v[32:47], v[96:99], v[160:163], v[32:47]
  v_mfma_f32_32x32x16_bf16 v[48:63], v[100:103], v[160:163], v[48:63]
  v_mfma_f32_32x32x16_bf16 v[64:79], v[96:99], v[164:167], v[64:79]
  v_mfma_f32_32x32x16_bf16 v[80:95], v[100:103], v[164:167], v[80:95]
  buffer_load_dwordx4 v[160:163], v4, s[16:19], s46 offen sc1
  buffer_load_dwordx4 v[164:167], v4, s[16:19], s47 offen sc1
  s_add_u32 s46, s46, 65536
  s_add_u32 s47, s47, 65536
  s_add_u32 s48, s48, 65536
  s_waitcnt vmcnt(20)
  s_waitcnt lgkmcnt(0)
  ds_read_b64_tr_b16 v[96:97], v12 offset:32768
  ds_read_b64_tr_b16 v[98:99], v12 offset:33280
  ds_read_b64_tr_b16 v[100:101], v13 offset:32768
  ds_read_b64_tr_b16 v[102:103], v13 offset:33280
  v_mfma_f32_32x32x16_bf16 v[32:47], v[104:107], v[168:171], v[32:47]
  v_mfma_f32_32x32x16_bf16 v[48:63], v[108:111], v[168:171], v[48:63]
  v_mfma_f32_32x32x16_bf16 v[64:79], v[104:107], v[172:175], v[64:79]
  v_mfma_f32_32x32x16_bf16 v[80:95], v[108:111], v[172:175], v[80:95]
  buffer_load_dwordx4 v[168:171], v4, s[16:19], s46 offen sc1
  buffer_load_dwordx4 v[172:175], v4, s[16:19], s47 offen sc1
  s_add_u32 s46, s46, 65536
  s_add_u32 s47, s47, 65536
  s_add_u32 s48, s48, 65536
  s_waitcnt vmcnt(18)
  s_waitcnt lgkmcnt(0)
  ds_read_b64_tr_b16 v[104:105], v12 offset:0
  ds_read_b64_tr_b16 v[106:107], v12 offset:512
  ds_read_b64_tr_b16 v[108:109], v13 offset:0
  ds_read_b64_tr_b16 v[110:111], v13 offset:512
  v_mfma_f32_32x32x16_bf16 v[32:47], v[96:99], v[112:115], v[32:47]
  v_mfma_f32_32x32x16_bf16 v[48:63], v[100:103], v[112:115], v[48:63]
  v_mfma_f32_32x32x16_bf16 v[64:79], v[96:99], v[116:119], v[64:79]
  v_mfma_f32_32x32x16_bf16 v[80:95], v[100:103], v[116:119], v[80:95]
  buffer_load_dwordx4 v[112:115], v4, s[16:19], s46 offen sc1
  buffer_load_dwordx4 v[116:119], v4, s[16:19], s47 offen sc1
  s_add_u32 s46, s46, 65536
  s_add_u32 s47, s47, 65536
  s_add_u32 s48, s48, 65536
  s_waitcnt vmcnt(16)
  s_waitcnt lgkmcnt(0)
  ds_read_b64_tr_b16 v[96:97], v12 offset:2048
  ds_read_b64_tr_b16 v[98:99], v12 offset:2560
  ds_read_b64_tr_b16 v[100:101], v13 offset:2048
  ds_read_b64_tr_b16 v[102:103], v13 offset:2560
  v_mfma_f32_32x32x16_bf16 v[32:47], v[104:107], v[120:123], v[32:47]
  v_mfma_f32_32x32x16_bf16 v[48:63], v[108:111], v[120:123], v[48:63]
  v_mfma_f32_32x32x16_bf16 v[64:79], v[104:107], v[124:127], v[64:79]
  v_mfma_f32_32x32x16_bf16 v[80:95], v[108:111], v[124:127], v[80:95]
  buffer_load_dwordx4 v[120:123], v4, s[16:19], s46 offen sc1
  buffer_load_dwordx4 v[124:127], v4, s[16:19], s47 offen sc1
  s_add_u32 s46, s46, 65536
  s_add_u32 s47, s47, 65536
  s_add_u32 s48, s48, 65536
  s_waitcnt vmcnt(14)
  s_waitcnt lgkmcnt(0)
  ds_read_b64_tr_b16 v[104:105], v12 offset:4096
  ds_read_b64_tr_b16 v[106:107], v12 offset:4608
  ds_read_b64_tr_b16 v[108:109], v13 offset:4096
  ds_read_b64_tr_b16 v[110:111], v13 offset:4608
  v_mfma_f32_32x32x16_bf16 v[32:47], v[96:99], v[128:131], v[32:47]
  v_mfma_f32_32x32x16_bf16 v[48:63], v[100:103], v[128:131], v[48:63]
  v_mfma_f32_32x32x16_bf16 v[64:79], v[96:99], v[132:135], v[64:79]
  v_mfma_f32_32x32x16_bf16 v[80:95], v[100:103], v[132:135], v[80:95]
  s_barrier
  buffer_load_dwordx4 v[128:131], v4, s[16:19], s46 offen sc1
  buffer_load_dwordx4 v[132:135], v4, s[16:19], s47 offen sc1
  s_add_u32 s46, s46, 65536
  s_add_u32 s47, s47, 65536
  s_add_u32 s48, s48, 65536
  s_waitcnt vmcnt(14)
  s_waitcnt lgkmcnt(0)
  ds_read_b64_tr_b16 v[96:97], v12 offset:6144
  ds_read_b64_tr_b16 v[98:99], v12 offset:6656
  ds_read_b64_tr_b16 v[100:101], v13 offset:6144
  ds_read_b64_tr_b16 v[102:103], v13 offset:6656
  v_mfma_f32_32x32x16_bf16 v[32:47], v[104:107], v[136:139], v[32:47]
  v_mfma_f32_32x32x16_bf16 v[48:63], v[108:111], v[136:139], v[48:63]
  v_mfma_f32_32x32x16_bf16 v[64:79], v[104:107], v[140:143], v[64:79]
  v_mfma_f32_32x32x16_bf16 v[80:95], v[108:111], v[140:143], v[80:95]
  buffer_load_dwordx4 v[136:139], v4, s[16:19], s46 offen sc1
  buffer_load_dwordx4 v[140:143], v4, s[16:19], s47 offen sc1
  s_add_u32 s46, s46, 65536
  s_add_u32 s47, s47, 65536
  s_add_u32 s48, s48, 65536
  s_waitcnt vmcnt(14)
  s_waitcnt lgkmcnt(0)
  ds_read_b64_tr_b16 v[104:105], v12 offset:8192
  ds_read_b64_tr_b16 v[106:107], v12 offset:8704
  ds_read_b64_tr_b16 v[108:109], v13 offset:8192
  ds_read_b64_tr_b16 v[110:111], v13 offset:8704
  v_mfma_f32_32x32x16_bf16 v[32:47], v[96:99], v[144:147], v[32:47]
  v_mfma_f32_32x32x16_bf16 v[48:63], v[100:103], v[144:147], v[48:63]
  v_mfma_f32_32x32x16_bf16 v[64:79], v[96:99], v[148:151], v[64:79]
  v_mfma_f32_32x32x16_bf16 v[80:95], v[100:103], v[148:151], v[80:95]
  s_waitcnt vmcnt(12)
  s_waitcnt lgkmcnt(0)
  ds_read_b64_tr_b16 v[96:97], v12 offset:10240
  ds_read_b64_tr_b16 v[98:99], v12 offset:10752
  ds_read_b64_tr_b16 v[100:101], v13 offset:10240
  ds_read_b64_tr_b16 v[102:103], v13 offset:10752
  v_mfma_f32_32x32x16_bf16 v[32:47], v[104:107], v[152:155], v[32:47]
  v_mfma_f32_32x32x16_bf16 v[48:63], v[108:111], v[152:155], v[48:63]
  v_mfma_f32_32x32x16_bf16 v[64:79], v[104:107], v[156:159], v[64:79]
  v_mfma_f32_32x32x16_bf16 v[80:95], v[108:111], v[156:159], v[80:95]
  s_waitcnt vmcnt(10)
  s_waitcnt lgkmcnt(0)
  ds_read_b64_tr_b16 v[104:105], v12 offset:12288
  ds_read_b64_tr_b16 v[106:107], v12 offset:12800
  ds_read_b64_tr_b16 v[108:109], v13 offset:12288
  ds_read_b64_tr_b16 v[110:111], v13 offset:12800
  v_mfma_f32_32x32x16_bf16 v[32:47], v[96:99], v[160:163], v[32:47]
  v_mfma_f32_32x32x16_bf16 v[48:63], v[100:103], v[160:163], v[48:63]
  v_mfma_f32_32x32x16_bf16 v[64:79], v[96:99], v[164:167], v[64:79]
  v_mfma_f32_32x32x16_bf16 v[80:95], v[100:103], v[164:167], v[80:95]
  s_waitcnt vmcnt(8)
  s_waitcnt lgkmcnt(0)
  ds_read_b64_tr_b16 v[96:97], v12 offset:14336
  ds_read_b64_tr_b16 v[98:99], v12 offset:14848
  ds_read_b64_tr_b16 v[100:101], v13 offset:14336
  ds_read_b64_tr_b16 v[102:103], v13 offset:14848
  v_mfma_f32_32x32x16_bf16 v[32:47], v[104:107], v[168:171], v[32:47]
  v_mfma_f32_32x32x16_bf16 v[48:63], v[108:111], v[168:171], v[48:63]
  v_mfma_f32_32x32x16_bf16 v[64:79], v[104:107], v[172:175], v[64:79]
  v_mfma_f32_32x32x16_bf16 v[80:95], v[108:111], v[172:175], v[80:95]
  s_waitcnt vmcnt(6)
  s_waitcnt lgkmcnt(0)
  s_mov_b32 s58, 0
lw_15:
  ds_read_b32 v24, v10 offset:4
  s_waitcnt lgkmcnt(0)
  v_readfirstlane_b32 s59, v24
  s_nop 2
  s_cmp_ge_u32 s59, 1
  s_cbranch_scc1 ld_16
  s_add_u32 s58, s58, 1
  s_cmp_lt_u32 s58, 131072
  s_cbranch_scc1 lw_15
ld_16:
  s_add_u32 m0, s45, 22528
  s_add_u32 s60, s52, 0
  buffer_load_dwordx4 v5, s[20:23], s60 offen sc1 lds
  s_add_u32 m0, s45, 23552
  s_add_u32 s60, s52, 32768
  buffer_load_dwordx4 v5, s[20:23], s60 offen sc1 lds
  s_add_u32 m0, s45, 24576
  s_add_u32 s60, s52, 65536
  buffer_load_dwordx4 v5, s[20:23], s60 offen sc1 lds
  s_add_u32 m0, s45, 25600
  s_add_u32 s60, s52, 98304
  buffer_load_dwordx4 v5, s[20:23], s60 offen sc1 lds
  s_add_u32 m0, s45, 26624
  s_add_u32 s60, s52, 131072
  buffer_load_dwordx4 v5, s[20:23], s60 offen sc1 lds
  s_add_u32 m0, s45, 27648
  s_add_u32 s60, s52, 163840
  buffer_load_dwordx4 v5, s[20:23], s60 offen sc1 lds
  s_add_u32 m0, s45, 28672
  s_add_u32 s60, s52, 196608
  buffer_load_dwordx4 v5, s[20:23], s60 offen sc1 lds
  s_add_u32 m0, s45, 29696
  s_add_u32 s60, s52, 229376
  buffer_load_dwordx4 v5, s[20:23], s60 offen sc1 lds
  s_add_u32 m0, s45, 30720
  s_add_u32 s60, s52, 262144
  buffer_load_dwordx4 v5, s[20:23], s60 offen sc1 lds
  s_add_u32 m0, s45, 31744
  s_add_u32 s60, s52, 294912
  buffer_load_dwordx4 v5, s[20:23], s60 offen sc1 lds
  s_add_u32 m0, s45, 32768
  s_add_u32 s60, s52, 327680
  buffer_load_dwordx4 v5, s[20:23], s60 offen sc1 lds
  s_add_u32 m0, s45, 33792
  s_add_u32 s60, s52, 360448
  buffer_load_dwordx4 v5, s[20:23], s60 offen sc1 lds
  s_add_u32 m0, s45, 0
  s_add_u32 s60, s52, 393216
  buffer_load_dwordx4 v5, s[20:23], s60 offen sc1 lds
  s_add_u32 m0, s45, 1024
  s_add_u32 s60, s52, 425984
  buffer_load_dwordx4 v5, s[20:23], s60 offen sc1 lds
  s_add_u32 m0, s45, 2048
  s_add_u32 s60, s52, 458752
  buffer_load_dwordx4 v5, s[20:23], s60 offen sc1 lds
  s_add_u32 m0, s45, 3072
  s_add_u32 s60, s52, 491520
  buffer_load_dwordx4 v5, s[20:23], s60 offen sc1 lds
  ds_read_b64_tr_b16 v[104:105], v12 offset:16384
  ds_read_b64_tr_b16 v[106:107], v12 offset:16896
  ds_read_b64_tr_b16 v[108:109], v13 offset:16384
  ds_read_b64_tr_b16 v[110:111], v13 offset:16896
  v_mfma_f32_32x32x16_bf16 v[32:47], v[96:99], v[112:115], v[32:47]
  v_mfma_f32_32x32x16_bf16 v[48:63], v[100:103], v[112:115], v[48:63]
  v_mfma_f32_32x32x16_bf16 v[64:79], v[96:99], v[116:119], v[64:79]
  v_mfma_f32_32x32x16_bf16 v[80:95], v[100:103], v[116:119], v[80:95]
  s_waitcnt vmcnt(20)
  s_waitcnt lgkmcnt(0)
  ds_read_b64_tr_b16 v[96:97], v12 offset:18432
  ds_read_b64_tr_b16 v[98:99], v12 offset:18944
  ds_read_b64_tr_b16 v[100:101], v13 offset:18432
  ds_read_b64_tr_b16 v[102:103], v13 offset:18944
  v_mfma_f32_32x32x16_bf16 v[32:47], v[104:107], v[120:123], v[32:47]
  v_mfma_f32_32x32x16_bf16 v[48:63], v[108:111], v[120:123], v[48:63]
  v_mfma_f32_32x32x16_bf16 v[64:79], v[104:107], v[124:127], v[64:79]
  v_mfma_f32_32x32x16_bf16 v[80:95], v[108:111], v[124:127], v[80:95]
  s_waitcnt vmcnt(18)
  s_waitcnt lgkmcnt(0)
  ds_read_b64_tr_b16 v[104:105], v12 offset:20480
  ds_read_b64_tr_b16 v[106:107], v12 offset:20992
  ds_read_b64_tr_b16 v[108:109], v13 offset:20480
  ds_read_b64_tr_b16 v[110:111], v13 offset:20992
  v_mfma_f32_32x32x16_bf16 v[32:47], v[96:99], v[128:131], v[32:47]
  v_mfma_f32_32x32x16_bf16 v[48:63], v[100:103], v[128:131], v[48:63]
  v_mfma_f32_32x32x16_bf16 v[64:79], v[96:99], v[132:135], v[64:79]
  v_mfma_f32_32x32x16_bf16 v[80:95], v[100:103], v[132:135], v[80:95]
  s_waitcnt vmcnt(14)
  s_waitcnt lgkmcnt(0)
  ds_read_b64_tr_b16 v[96:97], v6 offset:22528
  ds_read_b64_tr_b16 v[98:99], v6 offset:23040
  ds_read_b64_tr_b16 v[100:101], v7 offset:22528
  ds_read_b64_tr_b16 v[102:103], v7 offset:23040
  v_mfma_f32_32x32x16_bf16 v[32:47], v[104:107], v[136:139], v[32:47]
  v_mfma_f32_32x32x16_bf16 v[48:63], v[108:111], v[136:139], v[48:63]
  v_mfma_f32_32x32x16_bf16 v[64:79], v[104:107], v[140:143], v[64:79]
  v_mfma_f32_32x32x16_bf16 v[80:95], v[108:111], v[140:143], v[80:95]
  s_waitcnt vmcnt(12)
  s_waitcnt lgkmcnt(0)
  ds_read_b64_tr_b16 v[104:105], v6 offset:24576
  ds_read_b64_tr_b16 v[106:107], v6 offset:25088
  ds_read_b64_tr_b16 v[108:109], v7 offset:24576
  ds_read_b64_tr_b16 v[110:111], v7 offset:25088
  v_mfma_f32_32x32x16_bf16 v[32:47], v[176:179], v[96:99], v[32:47]
  v_mfma_f32_32x32x16_bf16 v[48:63], v[180:183], v[96:99], v[48:63]
  v_mfma_f32_32x32x16_bf16 v[64:79], v[176:179], v[100:103], v[64:79]
  v_mfma_f32_32x32x16_bf16 v[80:95], v[180:183], v[100:103], v[80:95]
  s_waitcnt vmcnt(10)
  s_waitcnt lgkmcnt(0)
  ds_read_b64_tr_b16 v[96:97], v6 offset:26624
  ds_read_b64_tr_b16 v[98:99], v6 offset:27136
  ds_read_b64_tr_b16 v[100:101], v7 offset:26624
  ds_read_b64_tr_b16 v[102:103], v7 offset:27136
  v_mfma_f32_32x32x16_bf16 v[32:47], v[184:187], v[104:107], v[32:47]
  v_mfma_f32_32x32x16_bf16 v[48:63], v[188:191], v[104:107], v[48:63]
  v_mfma_f32_32x32x16_bf16 v[64:79], v[184:187], v[108:111], v[64:79]
  v_mfma_f32_32x32x16_bf16 v[80:95], v[188:191], v[108:111], v[80:95]
  s_waitcnt vmcnt(8)
  s_waitcnt lgkmcnt(0)
  ds_read_b64_tr_b16 v[104:105], v6 offset:28672
  ds_read_b64_tr_b16 v[106:107], v6 offset:29184
  ds_read_b64_tr_b16 v[108:109], v7 offset:28672
  ds_read_b64_tr_b16 v[110:111], v7 offset:29184
  v_mfma_f32_32x32x16_bf16 v[32:47], v[192:195], v[96:99], v[32:47]
  v_mfma_f32_32x32x16_bf16 v[48:63], v[196:199], v[96:99], v[48:63]
  v_mfma_f32_32x32x16_bf16 v[64:79], v[192:195], v[100:103], v[64:79]
  v_mfma_f32_32x32x16_bf16 v[80:95], v[196:199], v[100:103], v[80:95]
  s_waitcnt vmcnt(6)
  s_waitcnt lgkmcnt(0)
  ds_read_b64_tr_b16 v[96:97], v6 offset:30720
  ds_read_b64_tr_b16 v[98:99], v6 offset:31232
  ds_read_b64_tr_b16 v[100:101], v7 offset:30720
  ds_read_b64_tr_b16 v[102:103], v7 offset:31232
  v_mfma_f32_32x32x16_bf16 v[32:47], v[200:203], v[104:107], v[32:47]
  v_mfma_f32_32x32x16_bf16 v[48:63], v[204:207], v[104:107], v[48:63]
  v_mfma_f32_32x32x16_bf16 v[64:79], v[200:203], v[108:111], v[64:79]
  v_mfma_f32_32x32x16_bf16 v[80:95], v[204:207], v[108:111], v[80:95]
  s_waitcnt vmcnt(4)
  s_waitcnt lgkmcnt(0)
  ds_read_b64_tr_b16 v[104:105], v6 offset:32768
  ds_read_b64_tr_b16 v[106:107], v6 offset:33280
  ds_read_b64_tr_b16 v[108:109], v7 offset:32768
  ds_read_b64_tr_b16 v[110:111], v7 offset:33280
  v_mfma_f32_32x32x16_bf16 v[32:47], v[208:211], v[96:99], v[32:47]
  v_mfma_f32_32x32x16_bf16 v[48:63], v[212:215], v[96:99], v[48:63]
  v_mfma_f32_32x32x16_bf16 v[64:79], v[208:211], v[100:103], v[64:79]
  v_mfma_f32_32x32x16_bf16 v[80:95], v[212:215], v[100:103], v[80:95]
  s_waitcnt vmcnt(2)
  s_waitcnt lgkmcnt(0)
  ds_read_b64_tr_b16 v[96:97], v6 offset:0
  ds_read_b64_tr_b16 v[98:99], v6 offset:512
  ds_read_b64_tr_b16 v[100:101], v7 offset:0
  ds_read_b64_tr_b16 v[102:103], v7 offset:512
  v_mfma_f32_32x32x16_bf16 v[32:47], v[216:219], v[104:107], v[32:47]
  v_mfma_f32_32x32x16_bf16 v[48:63], v[220:223], v[104:107], v[48:63]
  v_mfma_f32_32x32x16_bf16 v[64:79], v[216:219], v[108:111], v[64:79]
  v_mfma_f32_32x32x16_bf16 v[80:95], v[220:223], v[108:111], v[80:95]
  s_waitcnt vmcnt(0)
  s_waitcnt lgkmcnt(0)
  ds_read_b64_tr_b16 v[104:105], v6 offset:2048
  ds_read_b64_tr_b16 v[106:107], v6 offset:2560
  ds_read_b64_tr_b16 v[108:109], v7 offset:2048
  ds_read_b64_tr_b16 v[110:111], v7 offset:2560
  v_mfma_f32_32x32x16_bf16 v[32:47], v[224:227], v[96:99], v[32:47]
  v_mfma_f32_32x32x16_bf16 v[48:63], v[228:231], v[96:99], v[48:63]
  v_mfma_f32_32x32x16_bf16 v[64:79], v[224:227], v[100:103], v[64:79]
  v_mfma_f32_32x32x16_bf16 v[80:95], v[228:231], v[100:103], v[80:95]
  s_waitcnt lgkmcnt(0)
  v_mfma_f32_32x32x16_bf16 v[32:47], v[232:235], v[104:107], v[32:47]
  v_mfma_f32_32x32x16_bf16 v[48:63], v[236:239], v[104:107], v[48:63]
  v_mfma_f32_32x32x16_bf16 v[64:79], v[232:235], v[108:111], v[64:79]
  v_mfma_f32_32x32x16_bf16 v[80:95], v[236:239], v[108:111], v[80:95]
  buffer_load_dwordx2 v[16:17], v9, s[24:27], 0 offen offset:0
  buffer_load_dwordx2 v[18:19], v9, s[24:27], 0 offen offset:16
  buffer_load_dwordx2 v[20:21], v9, s[24:27], 0 offen offset:32
  buffer_load_dwordx2 v[22:23], v9, s[24:27], 0 offen offset:48
  s_mov_b32 s58, 0
lw_17:
  ds_read_b32 v24, v10 offset:48
  s_waitcnt lgkmcnt(0)
  v_readfirstlane_b32 s59, v24
  s_nop 2
  s_cmp_ge_u32 s59, 1
  s_cbranch_scc1 ld_18
  s_add_u32 s58, s58, 1
  s_cmp_lt_u32 s58, 131072
  s_cbranch_scc1 lw_17
ld_18:
  s_lshl_b32 s39, s15, 6
  s_lshl_b32 s31, s37, 5
  s_add_u32 s39, s39, s31
  v_add_u32 v30, s39, v3
  v_lshlrev_b32 v30, 1, v30
  s_mov_b32 s39, 2097152
  buffer_load_ushort v31, v30, s[20:23], s39 offen sc1
  v_lshlrev_b32 v14, 4, v1
  v_add_u32 v14, s45, v14
  ds_write_b128 v14, v[48:51] offset:0
  ds_write_b128 v14, v[52:55] offset:1024
  ds_write_b128 v14, v[56:59] offset:2048
  ds_write_b128 v14, v[60:63] offset:3072
  ds_write_b128 v14, v[64:67] offset:4096
  ds_write_b128 v14, v[68:71] offset:5120
  ds_write_b128 v14, v[72:75] offset:6144
  ds_write_b128 v14, v[76:79] offset:7168
  ds_write_b128 v14, v[80:83] offset:8192
  ds_write_b128 v14, v[84:87] offset:9216
  ds_write_b128 v14, v[88:91] offset:10240
  ds_write_b128 v14, v[92:95] offset:11264
  s_waitcnt lgkmcnt(0)
  s_barrier
  s_xor_b32 s39, s12, 1
  s_mul_i32 s39, s39, 34816
  v_lshlrev_b32 v15, 4, v1
  v_add_u32 v15, s39, v15
  ds_read_b128 v[112:115], v15 offset:0
  ds_read_b128 v[116:119], v15 offset:1024
  ds_read_b128 v[120:123], v15 offset:2048
  ds_read_b128 v[124:127], v15 offset:3072
  s_xor_b32 s39, s12, 2
  s_mul_i32 s39, s39, 34816
  v_lshlrev_b32 v15, 4, v1
  v_add_u32 v15, s39, v15
  ds_read_b128 v[128:131], v15 offset:4096
  ds_read_b128 v[132:135], v15 offset:5120
  ds_read_b128 v[136:139], v15 offset:6144
  ds_read_b128 v[140:143], v15 offset:7168
  s_xor_b32 s39, s12, 3
  s_mul_i32 s39, s39, 34816
  v_lshlrev_b32 v15, 4, v1
  v_add_u32 v15, s39, v15
  ds_read_b128 v[144:147], v15 offset:8192
  ds_read_b128 v[148:151], v15 offset:9216
  ds_read_b128 v[152:155], v15 offset:10240
  ds_read_b128 v[156:159], v15 offset:11264
  s_waitcnt lgkmcnt(8)
  v_add_f32 v32, v32, v112
  v_add_f32 v33, v33, v113
  v_add_f32 v34, v34, v114
  v_add_f32 v35, v35, v115
  v_add_f32 v36, v36, v116
  v_add_f32 v37, v37, v117
  v_add_f32 v38, v38, v118
  v_add_f32 v39, v39, v119
  v_add_f32 v40, v40, v120
  v_add_f32 v41, v41, v121
  v_add_f32 v42, v42, v122
  v_add_f32 v43, v43, v123
  v_add_f32 v44, v44, v124
  v_add_f32 v45, v45, v125
  v_add_f32 v46, v46, v126
  v_add_f32 v47, v47, v127
  s_waitcnt lgkmcnt(4)
  v_add_f32 v32, v32, v128
  v_add_f32 v33, v33, v129
  v_add_f32 v34, v34, v130
  v_add_f32 v35, v35, v131
  v_add_f32 v36, v36, v132
  v_add_f32 v37, v37, v133
  v_add_f32 v38, v38, v134
  v_add_f32 v39, v39, v135
  v_add_f32 v40, v40, v136
  v_add_f32 v41, v41, v137
  v_add_f32 v42, v42, v138
  v_add_f32 v43, v43, v139
  v_add_f32 v44, v44, v140
  v_add_f32 v45, v45, v141
  v_add_f32 v46, v46, v142
  v_add_f32 v47, v47, v143
  s_waitcnt lgkmcnt(0)
  v_add_f32 v32, v32, v144
  v_add_f32 v33, v33, v145
  v_add_f32 v34, v34, v146
  v_add_f32 v35, v35, v147
  v_add_f32 v36, v36, v148
  v_add_f32 v37, v37, v149
  v_add_f32 v38, v38, v150
  v_add_f32 v39, v39, v151
  v_add_f32 v40, v40, v152
  v_add_f32 v41, v41, v153
  v_add_f32 v42, v42, v154
  v_add_f32 v43, v43, v155
  v_add_f32 v44, v44, v156
  v_add_f32 v45, v45, v157
  v_add_f32 v46, v46, v158
  v_add_f32 v47, v47, v159
  s_waitcnt vmcnt(0)
  v_lshlrev_b32 v31, 16, v31
  v_add_f32 v32, v32, v31
  v_sub_f32 v33, v33, v31
  v_add_f32 v34, v34, v31
  v_sub_f32 v35, v35, v31
  v_add_f32 v36, v36, v31
  v_sub_f32 v37, v37, v31
  v_add_f32 v38, v38, v31
  v_sub_f32 v39, v39, v31
  v_add_f32 v40, v40, v31
  v_sub_f32 v41, v41, v31
  v_add_f32 v42, v42, v31
  v_sub_f32 v43, v43, v31
  v_add_f32 v44, v44, v31
  v_sub_f32 v45, v45, v31
  v_add_f32 v46, v46, v31
  v_sub_f32 v47, v47, v31
  v_lshlrev_b32 v24, 16, v16
  v_and_b32 v25, 0xffff0000, v16
  v_lshlrev_b32 v26, 16, v17
  v_and_b32 v27, 0xffff0000, v17
  v_add_f32 v32, v32, v24
  v_add_f32 v33, v33, v25
  v_add_f32 v34, v34, v26
  v_add_f32 v35, v35, v27
  v_cvt_pk_bf16_f32 v16, v32, v33
  v_cvt_pk_bf16_f32 v17, v34, v35
  buffer_store_dwordx2 v[16:17], v9, s[40:43], 0 offen offset:0
  v_lshlrev_b32 v24, 16, v18
  v_and_b32 v25, 0xffff0000, v18
  v_lshlrev_b32 v26, 16, v19
  v_and_b32 v27, 0xffff0000, v19
  v_add_f32 v36, v36, v24
  v_add_f32 v37, v37, v25
  v_add_f32 v38, v38, v26
  v_add_f32 v39, v39, v27
  v_cvt_pk_bf16_f32 v18, v36, v37
  v_cvt_pk_bf16_f32 v19, v38, v39
  buffer_store_dwordx2 v[18:19], v9, s[40:43], 0 offen offset:16
  v_lshlrev_b32 v24, 16, v20
  v_and_b32 v25, 0xffff0000, v20
  v_lshlrev_b32 v26, 16, v21
  v_and_b32 v27, 0xffff0000, v21
  v_add_f32 v40, v40, v24
  v_add_f32 v41, v41, v25
  v_add_f32 v42, v42, v26
  v_add_f32 v43, v43, v27
  v_cvt_pk_bf16_f32 v20, v40, v41
  v_cvt_pk_bf16_f32 v21, v42, v43
  buffer_store_dwordx2 v[20:21], v9, s[40:43], 0 offen offset:32
  v_lshlrev_b32 v24, 16, v22
  v_and_b32 v25, 0xffff0000, v22
  v_lshlrev_b32 v26, 16, v23
  v_and_b32 v27, 0xffff0000, v23
  v_add_f32 v44, v44, v24
  v_add_f32 v45, v45, v25
  v_add_f32 v46, v46, v26
  v_add_f32 v47, v47, v27
  v_cvt_pk_bf16_f32 v22, v44, v45
  v_cvt_pk_bf16_f32 v23, v46, v47
  buffer_store_dwordx2 v[22:23], v9, s[40:43], 0 offen offset:48
  s_endpgm
k_s2:
  s_sub_u32 s12, s32, 4
  v_and_b32 v1, 63, v0
  v_and_b32 v2, 15, v0
  v_bfe_u32 v3, v0, 4, 2
  v_mov_b32 v203, 163584
  s_lshl_b32 s33, s34, 4
  s_add_u32 s33, s33, s35
  s_mov_b32 s47, 0
  s_add_u32 s8, s4, 0x940000
  s_addc_u32 s9, s5, 0
  s_mov_b32 s10, 0x200000
  s_mov_b32 s11, 0x20000
  s_add_u32 s16, s4, 0xb40000
  s_addc_u32 s17, s5, 0
  s_mov_b32 s18, 0x202000
  s_mov_b32 s19, 0x20000
  s_add_u32 s20, s4, 0x700000
  s_addc_u32 s21, s5, 0
  s_mov_b32 s22, 0x202000
  s_mov_b32 s23, 0x20000
  s_lshl_b32 s13, s12, 11
  v_lshlrev_b32 v4, 7, v2
  v_lshl_add_u32 v4, v3, 4, v4
  v_add_u32 v4, s13, v4
  v_lshlrev_b32 v5, 4, v2
  v_lshl_add_u32 v5, v3, 8, v5
  v_add_u32 v5, s13, v5
  v_cvt_f32_u32 v6, v2
  v_lshlrev_b32 v184, 2, v3
  v_cvt_f32_u32 v7, v184
  s_lshl_b32 s13, s12, 4
  v_cvt_f32_u32 v185, s13
  v_mul_f32 v186, 0x3d000000, v6
  v_add_f32 v187, 0.5, v186
  v_add_f32 v188, v185, v6
  v_mul_f32 v191, 0x3a000000, v188
  v_mul_f32 v188, 0x3c800000, v188
  v_mul_f32 v189, 0x3a000000, v6
  v_add_f32 v190, 0x3c000000, v189
  v_add_f32 v192, v185, v7
  s_mov_b32 s46, 0x36000000
  s_cmp_eq_u32 s33, 0
  s_cselect_b32 s46, 0x35800000, s46
  v_mov_b32 v205, s46
  v_add_f32 v196, 0x00000000, v7
  v_mul_f32 v193, v196, v186
  v_cos_f32 v194, v193
  v_sin_f32 v195, v193
  s_nop 0
  v_cvt_pk_bf16_f32 v32, v194, v195
  v_cvt_pk_bf16_f32 v48, -v195, v194
  v_mul_f32 v193, v196, v187
  v_cos_f32 v194, v193
  v_sin_f32 v195, v193
  s_nop 0
  v_cvt_pk_bf16_f32 v36, v194, v195
  v_cvt_pk_bf16_f32 v52, -v195, v194
  v_add_f32 v196, 0x3f800000, v7
  v_mul_f32 v193, v196, v186
  v_cos_f32 v194, v193
  v_sin_f32 v195, v193
  s_nop 0
  v_cvt_pk_bf16_f32 v33, v194, v195
  v_cvt_pk_bf16_f32 v49, -v195, v194
  v_mul_f32 v193, v196, v187
  v_cos_f32 v194, v193
  v_sin_f32 v195, v193
  s_nop 0
  v_cvt_pk_bf16_f32 v37, v194, v195
  v_cvt_pk_bf16_f32 v53, -v195, v194
  v_add_f32 v196, 0x40000000, v7
  v_mul_f32 v193, v196, v186
  v_cos_f32 v194, v193
  v_sin_f32 v195, v193
  s_nop 0
  v_cvt_pk_bf16_f32 v34, v194, v195
  v_cvt_pk_bf16_f32 v50, -v195, v194
  v_mul_f32 v193, v196, v187
  v_cos_f32 v194, v193
  v_sin_f32 v195, v193
  s_nop 0
  v_cvt_pk_bf16_f32 v38, v194, v195
  v_cvt_pk_bf16_f32 v54, -v195, v194
  v_add_f32 v196, 0x40400000, v7
  v_mul_f32 v193, v196, v186
  v_cos_f32 v194, v193
  v_sin_f32 v195, v193
  s_nop 0
  v_cvt_pk_bf16_f32 v35, v194, v195
  v_cvt_pk_bf16_f32 v51, -v195, v194
  v_mul_f32 v193, v196, v187
  v_cos_f32 v194, v193
  v_sin_f32 v195, v193
  s_nop 0
  v_cvt_pk_bf16_f32 v39, v194, v195
  v_cvt_pk_bf16_f32 v55, -v195, v194
  v_add_f32 v196, 0x41800000, v7
  v_mul_f32 v193, v196, v186
  v_cos_f32 v194, v193
  v_sin_f32 v195, v193
  s_nop 0
  v_cvt_pk_bf16_f32 v40, v194, v195
  v_cvt_pk_bf16_f32 v56, -v195, v194
  v_mul_f32 v193, v196, v187
  v_cos_f32 v194, v193
  v_sin_f32 v195, v193
  s_nop 0
  v_cvt_pk_bf16_f32 v44, v194, v195
  v_cvt_pk_bf16_f32 v60, -v195, v194
  v_add_f32 v196, 0x41880000, v7
  v_mul_f32 v193, v196, v186
  v_cos_f32 v194, v193
  v_sin_f32 v195, v193
  s_nop 0
  v_cvt_pk_bf16_f32 v41, v194, v195
  v_cvt_pk_bf16_f32 v57, -v195, v194
  v_mul_f32 v193, v196, v187
  v_cos_f32 v194, v193
  v_sin_f32 v195, v193
  s_nop 0
  v_cvt_pk_bf16_f32 v45, v194, v195
  v_cvt_pk_bf16_f32 v61, -v195, v194
  v_add_f32 v196, 0x41900000, v7
  v_mul_f32 v193, v196, v186
  v_cos_f32 v194, v193
  v_sin_f32 v195, v193
  s_nop 0
  v_cvt_pk_bf16_f32 v42, v194, v195
  v_cvt_pk_bf16_f32 v58, -v195, v194
  v_mul_f32 v193, v196, v187
  v_cos_f32 v194, v193
  v_sin_f32 v195, v193
  s_nop 0
  v_cvt_pk_bf16_f32 v46, v194, v195
  v_cvt_pk_bf16_f32 v62, -v195, v194
  v_add_f32 v196, 0x41980000, v7
  v_mul_f32 v193, v196, v186
  v_cos_f32 v194, v193
  v_sin_f32 v195, v193
  s_nop 0
  v_cvt_pk_bf16_f32 v43, v194, v195
  v_cvt_pk_bf16_f32 v59, -v195, v194
  v_mul_f32 v193, v196, v187
  v_cos_f32 v194, v193
  v_sin_f32 v195, v193
  s_nop 0
  v_cvt_pk_bf16_f32 v47, v194, v195
  v_cvt_pk_bf16_f32 v63, -v195, v194
  v_add_f32 v196, 0x00000000, v192
  v_mul_f32 v193, v196, v189
  v_cos_f32 v96, v193
  v_sin_f32 v104, v193
  v_mul_f32 v193, v196, v190
  v_cos_f32 v100, v193
  v_sin_f32 v108, v193
  v_add_f32 v196, 0x3f800000, v192
  v_mul_f32 v193, v196, v189
  v_cos_f32 v97, v193
  v_sin_f32 v105, v193
  v_mul_f32 v193, v196, v190
  v_cos_f32 v101, v193
  v_sin_f32 v109, v193
  v_add_f32 v196, 0x40000000, v192
  v_mul_f32 v193, v196, v189
  v_cos_f32 v98, v193
  v_sin_f32 v106, v193
  v_mul_f32 v193, v196, v190
  v_cos_f32 v102, v193
  v_sin_f32 v110, v193
  v_add_f32 v196, 0x40400000, v192
  v_mul_f32 v193, v196, v189
  v_cos_f32 v99, v193
  v_sin_f32 v107, v193
  v_mul_f32 v193, v196, v190
  v_cos_f32 v103, v193
  v_sin_f32 v111, v193
  v_add_f32 v196, 0x00000000, v7
  v_mul_f32 v193, v196, v188
  v_cos_f32 v194, v193
  v_sin_f32 v195, v193
  s_nop 0
  v_cvt_pk_bf16_f32 v64, v194, v195
  v_cvt_pk_bf16_f32 v80, -v195, v194
  v_add_f32 v196, 0x3f800000, v7
  v_mul_f32 v193, v196, v188
  v_cos_f32 v194, v193
  v_sin_f32 v195, v193
  s_nop 0
  v_cvt_pk_bf16_f32 v65, v194, v195
  v_cvt_pk_bf16_f32 v81, -v195, v194
  v_add_f32 v196, 0x40000000, v7
  v_mul_f32 v193, v196, v188
  v_cos_f32 v194, v193
  v_sin_f32 v195, v193
  s_nop 0
  v_cvt_pk_bf16_f32 v66, v194, v195
  v_cvt_pk_bf16_f32 v82, -v195, v194
  v_add_f32 v196, 0x40400000, v7
  v_mul_f32 v193, v196, v188
  v_cos_f32 v194, v193
  v_sin_f32 v195, v193
  s_nop 0
  v_cvt_pk_bf16_f32 v67, v194, v195
  v_cvt_pk_bf16_f32 v83, -v195, v194
  v_add_f32 v196, 0x41800000, v7
  v_mul_f32 v193, v196, v188
  v_cos_f32 v194, v193
  v_sin_f32 v195, v193
  s_nop 0
  v_cvt_pk_bf16_f32 v68, v194, v195
  v_cvt_pk_bf16_f32 v84, -v195, v194
  v_add_f32 v196, 0x41880000, v7
  v_mul_f32 v193, v196, v188
  v_cos_f32 v194, v193
  v_sin_f32 v195, v193
  s_nop 0
  v_cvt_pk_bf16_f32 v69, v194, v195
  v_cvt_pk_bf16_f32 v85, -v195, v194
  v_add_f32 v196, 0x41900000, v7
  v_mul_f32 v193, v196, v188
  v_cos_f32 v194, v193
  v_sin_f32 v195, v193
  s_nop 0
  v_cvt_pk_bf16_f32 v70, v194, v195
  v_cvt_pk_bf16_f32 v86, -v195, v194
  v_add_f32 v196, 0x41980000, v7
  v_mul_f32 v193, v196, v188
  v_cos_f32 v194, v193
  v_sin_f32 v195, v193
  s_nop 0
  v_cvt_pk_bf16_f32 v71, v194, v195
  v_cvt_pk_bf16_f32 v87, -v195, v194
  v_add_f32 v196, 0x42000000, v7
  v_mul_f32 v193, v196, v188
  v_cos_f32 v194, v193
  v_sin_f32 v195, v193
  s_nop 0
  v_cvt_pk_bf16_f32 v72, v194, v195
  v_cvt_pk_bf16_f32 v88, -v195, v194
  v_add_f32 v196, 0x42040000, v7
  v_mul_f32 v193, v196, v188
  v_cos_f32 v194, v193
  v_sin_f32 v195, v193
  s_nop 0
  v_cvt_pk_bf16_f32 v73, v194, v195
  v_cvt_pk_bf16_f32 v89, -v195, v194
  v_add_f32 v196, 0x42080000, v7
  v_mul_f32 v193, v196, v188
  v_cos_f32 v194, v193
  v_sin_f32 v195, v193
  s_nop 0
  v_cvt_pk_bf16_f32 v74, v194, v195
  v_cvt_pk_bf16_f32 v90, -v195, v194
  v_add_f32 v196, 0x420c0000, v7
  v_mul_f32 v193, v196, v188
  v_cos_f32 v194, v193
  v_sin_f32 v195, v193
  s_nop 0
  v_cvt_pk_bf16_f32 v75, v194, v195
  v_cvt_pk_bf16_f32 v91, -v195, v194
  v_add_f32 v196, 0x42400000, v7
  v_mul_f32 v193, v196, v188
  v_cos_f32 v194, v193
  v_sin_f32 v195, v193
  s_nop 0
  v_cvt_pk_bf16_f32 v76, v194, v195
  v_cvt_pk_bf16_f32 v92, -v195, v194
  v_add_f32 v196, 0x42440000, v7
  v_mul_f32 v193, v196, v188
  v_cos_f32 v194, v193
  v_sin_f32 v195, v193
  s_nop 0
  v_cvt_pk_bf16_f32 v77, v194, v195
  v_cvt_pk_bf16_f32 v93, -v195, v194
  v_add_f32 v196, 0x42480000, v7
  v_mul_f32 v193, v196, v188
  v_cos_f32 v194, v193
  v_sin_f32 v195, v193
  s_nop 0
  v_cvt_pk_bf16_f32 v78, v194, v195
  v_cvt_pk_bf16_f32 v94, -v195, v194
  v_add_f32 v196, 0x424c0000, v7
  v_mul_f32 v193, v196, v188
  v_cos_f32 v194, v193
  v_sin_f32 v195, v193
  s_nop 0
  v_cvt_pk_bf16_f32 v79, v194, v195
  v_cvt_pk_bf16_f32 v95, -v195, v194
  v_add_f32 v196, 0x00000000, v7
  v_mul_f32 v193, v196, v191
  v_cos_f32 v112, v193
  v_sin_f32 v120, v193
  v_mul_f32 v112, v112, v205
  v_mul_f32 v120, v120, v205
  v_add_f32 v196, 0x3f800000, v7
  v_mul_f32 v193, v196, v191
  v_cos_f32 v113, v193
  v_sin_f32 v121, v193
  v_mul_f32 v113, v113, v205
  v_mul_f32 v121, v121, v205
  v_add_f32 v196, 0x40000000, v7
  v_mul_f32 v193, v196, v191
  v_cos_f32 v114, v193
  v_sin_f32 v122, v193
  v_mul_f32 v114, v114, v205
  v_mul_f32 v122, v122, v205
  v_add_f32 v196, 0x40400000, v7
  v_mul_f32 v193, v196, v191
  v_cos_f32 v115, v193
  v_sin_f32 v123, v193
  v_mul_f32 v115, v115, v205
  v_mul_f32 v123, v123, v205
  v_add_f32 v196, 0x41800000, v7
  v_mul_f32 v193, v196, v191
  v_cos_f32 v116, v193
  v_sin_f32 v124, v193
  v_mul_f32 v116, v116, v205
  v_mul_f32 v124, v124, v205
  v_add_f32 v196, 0x41880000, v7
  v_mul_f32 v193, v196, v191
  v_cos_f32 v117, v193
  v_sin_f32 v125, v193
  v_mul_f32 v117, v117, v205
  v_mul_f32 v125, v125, v205
  v_add_f32 v196, 0x41900000, v7
  v_mul_f32 v193, v196, v191
  v_cos_f32 v118, v193
  v_sin_f32 v126, v193
  v_mul_f32 v118, v118, v205
  v_mul_f32 v126, v126, v205
  v_add_f32 v196, 0x41980000, v7
  v_mul_f32 v193, v196, v191
  v_cos_f32 v119, v193
  v_sin_f32 v127, v193
  v_mul_f32 v119, v119, v205
  v_mul_f32 v127, v127, v205
  v_lshlrev_b32 v198, 4, v1
  v_add_u32 v198, 139264, v198
  s_lshl_b32 s13, s12, 11
  v_add_u32 v197, s13, v198
  s_lshl_b32 s13, s12, 2
  v_add_u32 v204, s13, v203
  s_mov_b32 s26, 0x80000000
  s_mov_b32 s27, 0x8000
  s_waitcnt vmcnt(0)
  s_barrier
  s_setprio 3
  s_cmp_lg_u32 s32, 4
  s_cbranch_scc1 s2_w1
  s_add_u32 s59, s34, 48
  s_lshl_b32 s59, s59, 7
  v_mov_b32 v152, s59
  v_mov_b32 v153, 16
  s_add_u32 s62, s4, 0x1000000
  s_addc_u32 s63, s5, 0
  s_mov_b32 s58, 0
  s_mov_b64 exec, 1
pc_19:
  global_load_dword v154, v152, s[62:63] sc1
  s_waitcnt vmcnt(0)
pk_21:
  v_cmp_ne_u32 vcc, v154, v153
  s_cbranch_vccz pd_20
  s_add_u32 s58, s58, 1
  s_cmp_lt_u32 s58, 8192
  s_cbranch_scc1 pc_19
pd_20:
  s_mov_b64 exec, -1
  v_mov_b32 v152, 1
  ds_write_b32 v203, v152 offset:8
s2_w1:
  s_mov_b32 s58, 0
lw_22:
  ds_read_b32 v152, v203 offset:8
  s_waitcnt lgkmcnt(0)
  v_readfirstlane_b32 s59, v152
  s_nop 2
  s_cmp_ge_u32 s59, 1
  s_cbranch_scc1 ld_23
  s_add_u32 s58, s58, 1
  s_cmp_lt_u32 s58, 131072
  s_cbranch_scc1 lw_22
ld_23:
s2_col:
  s_and_b32 s14, s33, 255
  s_lshl_b32 s14, s14, 13
  s_lshl_b32 s15, s33, 13
  s_add_u32 s29, s15, 4096
  buffer_load_dwordx4 v[16:19], v4, s[8:11], s14 offen sc1
  buffer_load_dwordx4 v[20:23], v4, s[8:11], s14 offen offset:64 sc1
  buffer_load_dwordx4 v[24:27], v5, s[16:19], s15 offen sc1
  buffer_load_dwordx4 v[28:31], v5, s[16:19], s15 offen offset:1024 sc1
  s_cmp_eq_u32 s33, 256
  s_cselect_b32 s24, 16, 0
  s_and_b32 s25, s33, 255
  s_cmp_eq_u32 s25, 0
  s_cselect_b32 s25, 0xffff, -1
  s_cmp_lg_u32 s33, 0
  s_cbranch_scc1 s2_nx
  s_mov_b32 s60, 0x200000
  buffer_load_dwordx4 v[208:211], v5, s[16:19], s60 offen sc1
  buffer_load_dwordx4 v[212:215], v5, s[16:19], s60 offen offset:1024 sc1
  s_waitcnt vmcnt(4)
  s_branch s2_ld
s2_nx:
  s_waitcnt vmcnt(2)
s2_ld:
  v_mov_b32 v216, v16
  v_mov_b32 v217, v17
  v_mov_b32 v218, v18
  v_mov_b32 v219, v19
  v_mov_b32 v220, v20
  v_mov_b32 v221, v21
  v_mov_b32 v222, v22
  v_mov_b32 v223, v23
s2_cmp:
  v_lshrrev_b32 v16, s24, v16
  v_lshrrev_b32 v17, s24, v17
  v_lshrrev_b32 v18, s24, v18
  v_lshrrev_b32 v19, s24, v19
  v_lshrrev_b32 v20, s24, v20
  v_lshrrev_b32 v21, s24, v21
  v_lshrrev_b32 v22, s24, v22
  v_lshrrev_b32 v23, s24, v23
  v_and_b32 v16, s25, v16
  v_and_b32 v17, s25, v17
  v_and_b32 v18, s25, v18
  v_and_b32 v19, s25, v19
  v_and_b32 v20, s25, v20
  v_and_b32 v21, s25, v21
  v_and_b32 v22, s25, v22
  v_and_b32 v23, s25, v23
  v_mfma_f32_16x16x32_bf16 v[128:131], v[16:19], v[32:35], 0
  s_nop 0
  v_mfma_f32_16x16x32_bf16 v[128:131], v[20:23], v[40:43], v[128:131]
  v_mfma_f32_16x16x32_bf16 v[136:139], v[16:19], v[48:51], 0
  v_mfma_f32_16x16x32_bf16 v[136:139], v[20:23], v[56:59], v[136:139]
  v_mfma_f32_16x16x32_bf16 v[132:135], v[16:19], v[36:39], 0
  v_mfma_f32_16x16x32_bf16 v[132:135], v[20:23], v[44:47], v[132:135]
  v_mfma_f32_16x16x32_bf16 v[140:143], v[16:19], v[52:55], 0
  v_mfma_f32_16x16x32_bf16 v[140:143], v[20:23], v[60:63], v[140:143]
  s_nop 1
  v_mul_f32 v199, v128, v96
  s_nop 0
  v_mul_f32 v200, v136, v96
  v_fma_f32 v199, v136, v104, v199
  v_fma_f32 v200, -v128, v104, v200
  v_cvt_pk_bf16_f32 v144, v199, v200
  v_mul_f32 v199, v129, v97
  v_mul_f32 v200, v137, v97
  v_fma_f32 v199, v137, v105, v199
  v_fma_f32 v200, -v129, v105, v200
  v_cvt_pk_bf16_f32 v145, v199, v200
  v_mul_f32 v199, v130, v98
  v_mul_f32 v200, v138, v98
  v_fma_f32 v199, v138, v106, v199
  v_fma_f32 v200, -v130, v106, v200
  v_cvt_pk_bf16_f32 v146, v199, v200
  v_mul_f32 v199, v131, v99
  v_mul_f32 v200, v139, v99
  v_fma_f32 v199, v139, v107, v199
  v_fma_f32 v200, -v131, v107, v200
  v_cvt_pk_bf16_f32 v147, v199, v200
  v_mul_f32 v199, v132, v100
  v_mul_f32 v200, v140, v100
  v_fma_f32 v199, v140, v108, v199
  v_fma_f32 v200, -v132, v108, v200
  v_cvt_pk_bf16_f32 v148, v199, v200
  v_mul_f32 v199, v133, v101
  v_mul_f32 v200, v141, v101
  v_fma_f32 v199, v141, v109, v199
  v_fma_f32 v200, -v133, v109, v200
  v_cvt_pk_bf16_f32 v149, v199, v200
  v_mul_f32 v199, v134, v102
  v_mul_f32 v200, v142, v102
  v_fma_f32 v199, v142, v110, v199
  v_fma_f32 v200, -v134, v110, v200
  v_cvt_pk_bf16_f32 v150, v199, v200
  v_mul_f32 v199, v135, v103
  v_mul_f32 v200, v143, v103
  v_fma_f32 v199, v143, v111, v199
  v_fma_f32 v200, -v135, v111, v200
  v_cvt_pk_bf16_f32 v151, v199, v200
  ds_write_b128 v197, v[144:147] offset:0
  ds_write_b128 v197, v[148:151] offset:1024
  s_add_u32 s46, s47, 1
  v_mov_b32 v199, s46
  ds_write_b32 v204, v199 offset:16
  s_mov_b32 s58, 0
lw_24:
  ds_read_b128 v[152:155], v203 offset:16
  s_waitcnt lgkmcnt(0)
  v_min_u32 v152, v152, v153
  v_min_u32 v154, v154, v155
  v_min_u32 v152, v152, v154
  s_nop 0
  v_readfirstlane_b32 s59, v152
  s_nop 2
  s_cmp_ge_u32 s59, s46
  s_cbranch_scc1 ld_25
  s_add_u32 s58, s58, 1
  s_cmp_lt_u32 s58, 131072
  s_cbranch_scc1 lw_24
ld_25:
  ds_read_b128 v[152:155], v198 offset:0
  ds_read_b128 v[156:159], v198 offset:1024
  ds_read_b128 v[160:163], v198 offset:2048
  ds_read_b128 v[164:167], v198 offset:3072
  ds_read_b128 v[168:171], v198 offset:4096
  ds_read_b128 v[172:175], v198 offset:5120
  ds_read_b128 v[176:179], v198 offset:6144
  ds_read_b128 v[180:183], v198 offset:7168
  s_waitcnt lgkmcnt(6)
  v_mfma_f32_16x16x32_bf16 v[128:131], v[64:67], v[152:155], 0
  v_mfma_f32_16x16x32_bf16 v[136:139], v[80:83], v[152:155], 0
  v_mfma_f32_16x16x32_bf16 v[132:135], v[64:67], v[156:159], 0
  v_mfma_f32_16x16x32_bf16 v[140:143], v[80:83], v[156:159], 0
  s_waitcnt lgkmcnt(4)
  v_mfma_f32_16x16x32_bf16 v[128:131], v[68:71], v[160:163], v[128:131]
  v_mfma_f32_16x16x32_bf16 v[136:139], v[84:87], v[160:163], v[136:139]
  v_mfma_f32_16x16x32_bf16 v[132:135], v[68:71], v[164:167], v[132:135]
  v_mfma_f32_16x16x32_bf16 v[140:143], v[84:87], v[164:167], v[140:143]
  s_waitcnt lgkmcnt(2)
  v_mfma_f32_16x16x32_bf16 v[128:131], v[72:75], v[168:171], v[128:131]
  v_mfma_f32_16x16x32_bf16 v[136:139], v[88:91], v[168:171], v[136:139]
  v_mfma_f32_16x16x32_bf16 v[132:135], v[72:75], v[172:175], v[132:135]
  v_mfma_f32_16x16x32_bf16 v[140:143], v[88:91], v[172:175], v[140:143]
  s_waitcnt lgkmcnt(0)
  v_mfma_f32_16x16x32_bf16 v[128:131], v[76:79], v[176:179], v[128:131]
  v_mfma_f32_16x16x32_bf16 v[136:139], v[92:95], v[176:179], v[136:139]
  v_mfma_f32_16x16x32_bf16 v[132:135], v[76:79], v[180:183], v[132:135]
  v_mfma_f32_16x16x32_bf16 v[140:143], v[92:95], v[180:183], v[140:143]
  s_cmp_eq_u32 s33, 256
  s_cbranch_scc1 s2_nw
  s_waitcnt vmcnt(0)
s2_nw:
  v_xor_b32 v32, s26, v32
  v_xor_b32 v48, s27, v48
  v_xor_b32 v33, s26, v33
  v_xor_b32 v49, s27, v49
  v_xor_b32 v34, s26, v34
  v_xor_b32 v50, s27, v50
  v_xor_b32 v35, s26, v35
  v_xor_b32 v51, s27, v51
  v_xor_b32 v36, s26, v36
  v_xor_b32 v52, s27, v52
  v_xor_b32 v37, s26, v37
  v_xor_b32 v53, s27, v53
  v_xor_b32 v38, s26, v38
  v_xor_b32 v54, s27, v54
  v_xor_b32 v39, s26, v39
  v_xor_b32 v55, s27, v55
  v_xor_b32 v40, s26, v40
  v_xor_b32 v56, s27, v56
  v_xor_b32 v41, s26, v41
  v_xor_b32 v57, s27, v57
  v_xor_b32 v42, s26, v42
  v_xor_b32 v58, s27, v58
  v_xor_b32 v43, s26, v43
  v_xor_b32 v59, s27, v59
  v_xor_b32 v44, s26, v44
  v_xor_b32 v60, s27, v60
  v_xor_b32 v45, s26, v45
  v_xor_b32 v61, s27, v61
  v_xor_b32 v46, s26, v46
  v_xor_b32 v62, s27, v62
  v_xor_b32 v47, s26, v47
  v_xor_b32 v63, s27, v63
  v_lshlrev_b32 v201, 16, v24
  v_and_b32 v202, 0xffff0000, v24
  v_mul_f32 v199, v128, v201
  v_mul_f32 v200, v136, v201
  v_fma_f32 v199, -v136, v202, v199
  v_fma_f32 v200, v128, v202, v200
  v_cvt_pk_bf16_f32 v144, v199, v200
  v_lshlrev_b32 v201, 16, v25
  v_and_b32 v202, 0xffff0000, v25
  v_mul_f32 v199, v129, v201
  v_mul_f32 v200, v137, v201
  v_fma_f32 v199, -v137, v202, v199
  v_fma_f32 v200, v129, v202, v200
  v_cvt_pk_bf16_f32 v145, v199, v200
  v_lshlrev_b32 v201, 16, v26
  v_and_b32 v202, 0xffff0000, v26
  v_mul_f32 v199, v130, v201
  v_mul_f32 v200, v138, v201
  v_fma_f32 v199, -v138, v202, v199
  v_fma_f32 v200, v130, v202, v200
  v_cvt_pk_bf16_f32 v146, v199, v200
  v_lshlrev_b32 v201, 16, v27
  v_and_b32 v202, 0xffff0000, v27
  v_mul_f32 v199, v131, v201
  v_mul_f32 v200, v139, v201
  v_fma_f32 v199, -v139, v202, v199
  v_fma_f32 v200, v131, v202, v200
  v_cvt_pk_bf16_f32 v147, v199, v200
  v_lshlrev_b32 v201, 16, v28
  v_and_b32 v202, 0xffff0000, v28
  v_mul_f32 v199, v132, v201
  v_mul_f32 v200, v140, v201
  v_fma_f32 v199, -v140, v202, v199
  v_fma_f32 v200, v132, v202, v200
  v_cvt_pk_bf16_f32 v148, v199, v200
  v_lshlrev_b32 v201, 16, v29
  v_and_b32 v202, 0xffff0000, v29
  v_mul_f32 v199, v133, v201
  v_mul_f32 v200, v141, v201
  v_fma_f32 v199, -v141, v202, v199
  v_fma_f32 v200, v133, v202, v200
  v_cvt_pk_bf16_f32 v149, v199, v200
  v_lshlrev_b32 v201, 16, v30
  v_and_b32 v202, 0xffff0000, v30
  v_mul_f32 v199, v134, v201
  v_mul_f32 v200, v142, v201
  v_fma_f32 v199, -v142, v202, v199
  v_fma_f32 v200, v134, v202, v200
  v_cvt_pk_bf16_f32 v150, v199, v200
  v_lshlrev_b32 v201, 16, v31
  v_and_b32 v202, 0xffff0000, v31
  v_mul_f32 v199, v135, v201
  v_mul_f32 v200, v143, v201
  v_fma_f32 v199, -v143, v202, v199
  v_fma_f32 v200, v135, v202, v200
  v_cvt_pk_bf16_f32 v151, v199, v200
  v_xor_b32 v64, s26, v64
  v_xor_b32 v80, s27, v80
  v_xor_b32 v65, s26, v65
  v_xor_b32 v81, s27, v81
  v_xor_b32 v66, s26, v66
  v_xor_b32 v82, s27, v82
  v_xor_b32 v67, s26, v67
  v_xor_b32 v83, s27, v83
  v_xor_b32 v68, s26, v68
  v_xor_b32 v84, s27, v84
  v_xor_b32 v69, s26, v69
  v_xor_b32 v85, s27, v85
  v_xor_b32 v70, s26, v70
  v_xor_b32 v86, s27, v86
  v_xor_b32 v71, s26, v71
  v_xor_b32 v87, s27, v87
  v_xor_b32 v72, s26, v72
  v_xor_b32 v88, s27, v88
  v_xor_b32 v73, s26, v73
  v_xor_b32 v89, s27, v89
  v_xor_b32 v74, s26, v74
  v_xor_b32 v90, s27, v90
  v_xor_b32 v75, s26, v75
  v_xor_b32 v91, s27, v91
  v_xor_b32 v76, s26, v76
  v_xor_b32 v92, s27, v92
  v_xor_b32 v77, s26, v77
  v_xor_b32 v93, s27, v93
  v_xor_b32 v78, s26, v78
  v_xor_b32 v94, s27, v94
  v_xor_b32 v79, s26, v79
  v_xor_b32 v95, s27, v95
  ds_write_b128 v197, v[144:147] offset:8192
  ds_write_b128 v197, v[148:151] offset:9216
  s_add_u32 s46, s47, 2
  v_mov_b32 v199, s46
  ds_write_b32 v204, v199 offset:16
  s_mov_b32 s58, 0
lw_26:
  ds_read_b128 v[152:155], v203 offset:16
  s_waitcnt lgkmcnt(0)
  v_min_u32 v152, v152, v153
  v_min_u32 v154, v154, v155
  v_min_u32 v152, v152, v154
  s_nop 0
  v_readfirstlane_b32 s59, v152
  s_nop 2
  s_cmp_ge_u32 s59, s46
  s_cbranch_scc1 ld_27
  s_add_u32 s58, s58, 1
  s_cmp_lt_u32 s58, 131072
  s_cbranch_scc1 lw_26
ld_27:
  ds_read_b128 v[152:155], v198 offset:8192
  ds_read_b128 v[156:159], v198 offset:9216
  ds_read_b128 v[160:163], v198 offset:10240
  ds_read_b128 v[164:167], v198 offset:11264
  ds_read_b128 v[168:171], v198 offset:12288
  ds_read_b128 v[172:175], v198 offset:13312
  ds_read_b128 v[176:179], v198 offset:14336
  ds_read_b128 v[180:183], v198 offset:15360
  s_cmp_lg_u32 s33, 256
  s_cbranch_scc1 s2_np
  s_waitcnt vmcnt(0)
  v_mov_b32 v200, 1
  ds_write_b32 v204, v200 offset:32
  s_cmp_lg_u32 s32, 4
  s_cbranch_scc1 s2_w2c
  s_mov_b32 s58, 0
lw_28:
  ds_read_b128 v[224:227], v203 offset:32
  s_waitcnt lgkmcnt(0)
  v_min_u32 v224, v224, v225
  v_min_u32 v226, v226, v227
  v_min_u32 v224, v224, v226
  s_nop 0
  v_readfirstlane_b32 s59, v224
  s_nop 2
  s_cmp_ge_u32 s59, 1
  s_cbranch_scc1 ld_29
  s_add_u32 s58, s58, 1
  s_cmp_lt_u32 s58, 131072
  s_cbranch_scc1 lw_28
ld_29:
  s_add_u32 s62, s4, 0x1000000
  s_addc_u32 s63, s5, 0
  v_lshlrev_b32 v228, 3, v1
  v_add_u32 v228, 64, v228
  v_lshlrev_b32 v228, 7, v228
  v_mov_b32 v229, 1
  s_mov_b64 exec, 65535
  global_atomic_add v228, v229, s[62:63] sc1
  s_mov_b64 exec, -1
s2_w2c:
  s_barrier
s2_np:
  s_waitcnt lgkmcnt(6)
  v_mfma_f32_16x16x32_bf16 v[128:131], v[152:155], v[64:67], 0
  v_mfma_f32_16x16x32_bf16 v[136:139], v[152:155], v[80:83], 0
  v_mfma_f32_16x16x32_bf16 v[132:135], v[156:159], v[64:67], 0
  v_mfma_f32_16x16x32_bf16 v[140:143], v[156:159], v[80:83], 0
  s_waitcnt lgkmcnt(4)
  v_mfma_f32_16x16x32_bf16 v[128:131], v[160:163], v[68:71], v[128:131]
  v_mfma_f32_16x16x32_bf16 v[136:139], v[160:163], v[84:87], v[136:139]
  v_mfma_f32_16x16x32_bf16 v[132:135], v[164:167], v[68:71], v[132:135]
  v_mfma_f32_16x16x32_bf16 v[140:143], v[164:167], v[84:87], v[140:143]
  s_waitcnt lgkmcnt(2)
  v_mfma_f32_16x16x32_bf16 v[128:131], v[168:171], v[72:75], v[128:131]
  v_mfma_f32_16x16x32_bf16 v[136:139], v[168:171], v[88:91], v[136:139]
  v_mfma_f32_16x16x32_bf16 v[132:135], v[172:175], v[72:75], v[132:135]
  v_mfma_f32_16x16x32_bf16 v[140:143], v[172:175], v[88:91], v[140:143]
  s_waitcnt lgkmcnt(0)
  v_mfma_f32_16x16x32_bf16 v[128:131], v[176:179], v[76:79], v[128:131]
  v_mfma_f32_16x16x32_bf16 v[136:139], v[176:179], v[92:95], v[136:139]
  v_mfma_f32_16x16x32_bf16 v[132:135], v[180:183], v[76:79], v[132:135]
  v_mfma_f32_16x16x32_bf16 v[140:143], v[180:183], v[92:95], v[140:143]
  s_nop 4
  v_mul_f32 v199, v128, v112
  v_mul_f32 v200, v136, v112
  v_fma_f32 v199, -v136, v120, v199
  v_fma_f32 v200, v128, v120, v200
  v_cvt_pk_bf16_f32 v144, v199, v200
  v_mul_f32 v199, v129, v113
  v_mul_f32 v200, v137, v113
  v_fma_f32 v199, -v137, v121, v199
  v_fma_f32 v200, v129, v121, v200
  v_cvt_pk_bf16_f32 v145, v199, v200
  v_mul_f32 v199, v130, v114
  v_mul_f32 v200, v138, v114
  v_fma_f32 v199, -v138, v122, v199
  v_fma_f32 v200, v130, v122, v200
  v_cvt_pk_bf16_f32 v146, v199, v200
  v_mul_f32 v199, v131, v115
  v_mul_f32 v200, v139, v115
  v_fma_f32 v199, -v139, v123, v199
  v_fma_f32 v200, v131, v123, v200
  v_cvt_pk_bf16_f32 v147, v199, v200
  v_mul_f32 v199, v132, v116
  v_mul_f32 v200, v140, v116
  v_fma_f32 v199, -v140, v124, v199
  v_fma_f32 v200, v132, v124, v200
  v_cvt_pk_bf16_f32 v148, v199, v200
  v_mul_f32 v199, v133, v117
  v_mul_f32 v200, v141, v117
  v_fma_f32 v199, -v141, v125, v199
  v_fma_f32 v200, v133, v125, v200
  v_cvt_pk_bf16_f32 v149, v199, v200
  v_mul_f32 v199, v134, v118
  v_mul_f32 v200, v142, v118
  v_fma_f32 v199, -v142, v126, v199
  v_fma_f32 v200, v134, v126, v200
  v_cvt_pk_bf16_f32 v150, v199, v200
  v_mul_f32 v199, v135, v119
  v_mul_f32 v200, v143, v119
  v_fma_f32 v199, -v143, v127, v199
  v_fma_f32 v200, v135, v127, v200
  v_cvt_pk_bf16_f32 v151, v199, v200
  v_mfma_f32_16x16x32_bf16 v[128:131], v[32:35], v[144:147], 0
  s_nop 0
  v_mfma_f32_16x16x32_bf16 v[128:131], v[40:43], v[148:151], v[128:131]
  v_mfma_f32_16x16x32_bf16 v[136:139], v[48:51], v[144:147], 0
  v_mfma_f32_16x16x32_bf16 v[136:139], v[56:59], v[148:151], v[136:139]
  v_mfma_f32_16x16x32_bf16 v[132:135], v[36:39], v[144:147], 0
  v_mfma_f32_16x16x32_bf16 v[132:135], v[44:47], v[148:151], v[132:135]
  v_mfma_f32_16x16x32_bf16 v[140:143], v[52:55], v[144:147], 0
  v_mfma_f32_16x16x32_bf16 v[140:143], v[60:63], v[148:151], v[140:143]
  v_lshrrev_b32 v199, 1, v4
  s_nop 0
  v_cvt_pk_bf16_f32 v152, v128, v129
  v_cvt_pk_bf16_f32 v153, v130, v131
  buffer_store_dwordx2 v[152:153], v199, s[20:23], s15 offen offset:0 sc1
  v_cvt_pk_bf16_f32 v154, v136, v137
  v_cvt_pk_bf16_f32 v155, v138, v139
  buffer_store_dwordx2 v[154:155], v199, s[20:23], s29 offen offset:0 sc1
  v_cvt_pk_bf16_f32 v156, v132, v133
  v_cvt_pk_bf16_f32 v157, v134, v135
  buffer_store_dwordx2 v[156:157], v199, s[20:23], s15 offen offset:32 sc1
  v_cvt_pk_bf16_f32 v158, v140, v141
  v_cvt_pk_bf16_f32 v159, v142, v143
  buffer_store_dwordx2 v[158:159], v199, s[20:23], s29 offen offset:32 sc1
  s_cmp_eq_u32 s33, 0
  s_cbranch_scc1 s2_second
  s_cmp_eq_u32 s33, 256
  s_cbranch_scc1 s2_pubn
  s_waitcnt vmcnt(0)
  v_mov_b32 v200, 1
  ds_write_b32 v204, v200 offset:32
  s_cmp_lg_u32 s32, 4
  s_cbranch_scc1 s2_w2a
  s_mov_b32 s58, 0
lw_30:
  ds_read_b128 v[224:227], v203 offset:32
  s_waitcnt lgkmcnt(0)
  v_min_u32 v224, v224, v225
  v_min_u32 v226, v226, v227
  v_min_u32 v224, v224, v226
  s_nop 0
  v_readfirstlane_b32 s59, v224
  s_nop 2
  s_cmp_ge_u32 s59, 1
  s_cbranch_scc1 ld_31
  s_add_u32 s58, s58, 1
  s_cmp_lt_u32 s58, 131072
  s_cbranch_scc1 lw_30
ld_31:
  s_add_u32 s62, s4, 0x1000000
  s_addc_u32 s63, s5, 0
  s_and_b32 s46, s33, 7
  s_add_u32 s46, s46, 64
  v_lshlrev_b32 v228, 3, v1
  v_add_u32 v228, s46, v228
  v_lshlrev_b32 v228, 7, v228
  v_mov_b32 v229, 1
  s_mov_b64 exec, 65535
  global_atomic_add v228, v229, s[62:63] sc1
  s_mov_b64 exec, -1
s2_w2a:
  s_barrier
  s_branch s2_fin
s2_pubn:
  s_waitcnt vmcnt(0)
  v_mov_b32 v200, 2
  ds_write_b32 v204, v200 offset:32
  s_cmp_lg_u32 s32, 4
  s_cbranch_scc1 s2_w2b
  s_mov_b32 s58, 0
lw_32:
  ds_read_b128 v[224:227], v203 offset:32
  s_waitcnt lgkmcnt(0)
  v_min_u32 v224, v224, v225
  v_min_u32 v226, v226, v227
  v_min_u32 v224, v224, v226
  s_nop 0
  v_readfirstlane_b32 s59, v224
  s_nop 2
  s_cmp_ge_u32 s59, 2
  s_cbranch_scc1 ld_33
  s_add_u32 s58, s58, 1
  s_cmp_lt_u32 s58, 131072
  s_cbranch_scc1 lw_32
ld_33:
  s_add_u32 s62, s4, 0x1000000
  s_addc_u32 s63, s5, 0
  v_add_u32 v228, 192, v1
  v_lshlrev_b32 v228, 7, v228
  v_mov_b32 v229, 1
  s_mov_b64 exec, 65535
  global_atomic_add v228, v229, s[62:63] sc1
  s_mov_b64 exec, -1
s2_w2b:
  s_branch s2_fin
s2_second:
  v_xor_b32 v32, s26, v32
  v_xor_b32 v48, s27, v48
  v_xor_b32 v33, s26, v33
  v_xor_b32 v49, s27, v49
  v_xor_b32 v34, s26, v34
  v_xor_b32 v50, s27, v50
  v_xor_b32 v35, s26, v35
  v_xor_b32 v51, s27, v51
  v_xor_b32 v36, s26, v36
  v_xor_b32 v52, s27, v52
  v_xor_b32 v37, s26, v37
  v_xor_b32 v53, s27, v53
  v_xor_b32 v38, s26, v38
  v_xor_b32 v54, s27, v54
  v_xor_b32 v39, s26, v39
  v_xor_b32 v55, s27, v55
  v_xor_b32 v40, s26, v40
  v_xor_b32 v56, s27, v56
  v_xor_b32 v41, s26, v41
  v_xor_b32 v57, s27, v57
  v_xor_b32 v42, s26, v42
  v_xor_b32 v58, s27, v58
  v_xor_b32 v43, s26, v43
  v_xor_b32 v59, s27, v59
  v_xor_b32 v44, s26, v44
  v_xor_b32 v60, s27, v60
  v_xor_b32 v45, s26, v45
  v_xor_b32 v61, s27, v61
  v_xor_b32 v46, s26, v46
  v_xor_b32 v62, s27, v62
  v_xor_b32 v47, s26, v47
  v_xor_b32 v63, s27, v63
  v_xor_b32 v64, s26, v64
  v_xor_b32 v80, s27, v80
  v_xor_b32 v65, s26, v65
  v_xor_b32 v81, s27, v81
  v_xor_b32 v66, s26, v66
  v_xor_b32 v82, s27, v82
  v_xor_b32 v67, s26, v67
  v_xor_b32 v83, s27, v83
  v_xor_b32 v68, s26, v68
  v_xor_b32 v84, s27, v84
  v_xor_b32 v69, s26, v69
  v_xor_b32 v85, s27, v85
  v_xor_b32 v70, s26, v70
  v_xor_b32 v86, s27, v86
  v_xor_b32 v71, s26, v71
  v_xor_b32 v87, s27, v87
  v_xor_b32 v72, s26, v72
  v_xor_b32 v88, s27, v88
  v_xor_b32 v73, s26, v73
  v_xor_b32 v89, s27, v89
  v_xor_b32 v74, s26, v74
  v_xor_b32 v90, s27, v90
  v_xor_b32 v75, s26, v75
  v_xor_b32 v91, s27, v91
  v_xor_b32 v76, s26, v76
  v_xor_b32 v92, s27, v92
  v_xor_b32 v77, s26, v77
  v_xor_b32 v93, s27, v93
  v_xor_b32 v78, s26, v78
  v_xor_b32 v94, s27, v94
  v_xor_b32 v79, s26, v79
  v_xor_b32 v95, s27, v95
  v_mov_b32 v16, v216
  v_mov_b32 v17, v217
  v_mov_b32 v18, v218
  v_mov_b32 v19, v219
  v_mov_b32 v20, v220
  v_mov_b32 v21, v221
  v_mov_b32 v22, v222
  v_mov_b32 v23, v223
  v_mov_b32 v24, v208
  v_mov_b32 v25, v209
  v_mov_b32 v26, v210
  v_mov_b32 v27, v211
  v_mov_b32 v28, v212
  v_mov_b32 v29, v213
  v_mov_b32 v30, v214
  v_mov_b32 v31, v215
  s_movk_i32 s33, 256
  s_mov_b32 s15, 0x200000
  s_add_u32 s29, s15, 4096
  s_mov_b32 s24, 16
  s_mov_b32 s25, 0xffff
  s_add_u32 s47, s47, 2
  s_branch s2_cmp
s2_fin:
  s_setprio 0
  s_cmp_lg_u32 s32, 4
  s_cbranch_scc1 s2_w3
  s_and_b32 s46, s2, 15
  s_lshl_b32 s46, s46, 3
  s_add_u32 s46, s46, 64
  v_add_u32 v152, s46, v1
  v_lshlrev_b32 v152, 7, v152
  v_mov_b32 v153, 32
  s_add_u32 s62, s4, 0x1000000
  s_addc_u32 s63, s5, 0
  s_mov_b32 s58, 0
  s_mov_b64 exec, 255
pc_34:
  global_load_dword v154, v152, s[62:63] sc1
  s_waitcnt vmcnt(0)
pk_36:
  v_cmp_ne_u32 vcc, v154, v153
  s_cbranch_vccz pd_35
  s_sleep 2
  s_add_u32 s58, s58, 1
  s_cmp_lt_u32 s58, 8192
  s_cbranch_scc1 pc_34
pd_35:
  s_mov_b64 exec, -1
  v_mov_b32 v152, 1
  ds_write_b32 v203, v152 offset:4
  s_and_b32 s46, s2, 15
  s_add_u32 s46, s46, 192
  s_lshl_b32 s46, s46, 7
  v_mov_b32 v152, s46
  v_mov_b32 v153, 1
  s_add_u32 s62, s4, 0x1000000
  s_addc_u32 s63, s5, 0
  s_mov_b32 s58, 0
  s_mov_b64 exec, 1
pc_37:
  global_load_dword v154, v152, s[62:63] sc1
  s_waitcnt vmcnt(0)
pk_39:
  v_cmp_ne_u32 vcc, v154, v153
  s_cbranch_vccz pd_38
  s_add_u32 s58, s58, 1
  s_cmp_lt_u32 s58, 8192
  s_cbranch_scc1 pc_37
pd_38:
  s_mov_b64 exec, -1
  v_mov_b32 v152, 1
  ds_write_b32 v203, v152 offset:48
s2_w3:
  s_waitcnt lgkmcnt(0)
  s_barrier
k_done:
  s_endpgm
.section .rodata,"a"
.p2align 6
.amdhsa_kernel parallel_sum__spectral_gfnet__glu_gated_geglu__prompt_kernel
  .amdhsa_next_free_vgpr 256
  .amdhsa_next_free_sgpr 100
  .amdhsa_accum_offset 256
  .amdhsa_group_segment_fixed_size 0
  .amdhsa_kernarg_size 80
  .amdhsa_user_sgpr_count 2
  .amdhsa_user_sgpr_kernarg_segment_ptr 1
  .amdhsa_system_sgpr_workgroup_id_x 1
  .amdhsa_float_denorm_mode_32 3
.end_amdhsa_kernel
```
